```python
import torch

def _softmax(x, axis=-1):
    return torch.softmax(x, dim=axis)
def _gelu(x):
    return torch.nn.functional.gelu(x, approximate="tanh")
def _silu(x):
    return torch.nn.functional.silu(x)
def _sigmoid(x):
    return torch.sigmoid(x)
def _layernorm(x, axis=-1, eps=1e-5):
    m = x.mean(dim=axis, keepdim=True)
    v = x.var(dim=axis, keepdim=True, unbiased=False)
    return (x - m) / torch.sqrt(v + eps)
def _scatter_add(tgt, idx, src, axis=0):
    return tgt.clone().index_add_(axis, idx, src)
def _segment_sum(src, seg, n):
    out = torch.zeros((n,) + src.shape[1:], dtype=src.dtype)
    return out.index_add_(0, seg, src)
def _pad(x, pw):
    flat = tuple(v for pair in reversed(pw) for v in pair)
    return torch.nn.functional.pad(x, flat)

kernel_name = 'interleave_layers__linear_kernel_hedgehog__spectral_fnet__prompt'

def setup_inputs():

    _w = (lambda a: (lambda t: t.to(torch.bfloat16) if t.is_floating_point() else t)(torch.as_tensor(a)))
    def _A_setup():
        B, S, D, H = 1, 2048, 448, 16
        Dh = D // H
        return {
            "x": _w((lambda *s: torch.randn(*s, dtype=torch.bfloat16) * 0.4)(B, S, D)),
            "wqkv": _w((lambda *s: torch.randn(*s, dtype=torch.bfloat16) * 1.6)(D, 3 * D)),
            "w_phi": _w((lambda *s: torch.randn(*s, dtype=torch.bfloat16) * 1.6)(H, Dh, Dh) * (Dh ** -0.5)),
            "wo": _w((lambda *s: torch.randn(*s, dtype=torch.bfloat16) * 1.6)(D, D)),
        }
    _A_in = _A_setup()

    def _B_setup():
        B, S, D = 1, 2048, 448
        ns = torch.arange(S)[:, None] * torch.arange(S)[None, :]
        nd = torch.arange(D)[:, None] * torch.arange(D)[None, :]
        Ws_re = torch.cos(-2.0 * torch.pi * ns / S).to(float)
        Ws_im = torch.sin(-2.0 * torch.pi * ns / S).to(float)
        Wd_re = torch.cos(-2.0 * torch.pi * nd / D).to(float)
        Wd_im = torch.sin(-2.0 * torch.pi * nd / D).to(float)
        return {
            "x": _w((lambda *s: torch.randn(*s, dtype=torch.bfloat16) * 0.4)(B, S, D)),
            "dft_seq_re": _w(Ws_re),
            "dft_seq_im": _w(Ws_im),
            "dft_hid_re": _w(Wd_re),
            "dft_hid_im": _w(Wd_im),
        }
    _B_in = _B_setup()

    return {
        "A_x": _A_in["x"],
        "A_wqkv": _A_in["wqkv"],
        "A_w_phi": _A_in["w_phi"],
        "A_wo": _A_in["wo"],
        "B_x": _B_in["x"],
        "B_dft_seq_re": _B_in["dft_seq_re"],
        "B_dft_seq_im": _B_in["dft_seq_im"],
        "B_dft_hid_re": _B_in["dft_hid_re"],
        "B_dft_hid_im": _B_in["dft_hid_im"],
    }

def reference(A_x, A_wqkv, A_w_phi, A_wo, B_x, B_dft_seq_re, B_dft_seq_im, B_dft_hid_re, B_dft_hid_im):
    def _A_ref(x, wqkv, w_phi, wo):
        B, S, D = x.shape
        H = 16; Dh = D // H
        qkv = (lambda x, *d: x.permute(*d))((x @ wqkv).reshape(B, S, 3, H, Dh), 2, 0, 3, 1, 4)
        q, k, v = qkv[0], qkv[1], qkv[2]
        pq = torch.einsum("bhsd,hdf->bhsf", q, w_phi)
        pk = torch.einsum("bhsd,hdf->bhsf", k, w_phi)
        phi_q = torch.concatenate([_softmax(pq, axis=-1), _softmax(-pq, axis=-1)], axis=-1)
        phi_k = torch.concatenate([_softmax(pk, axis=-1), _softmax(-pk, axis=-1)], axis=-1)
        kv = torch.einsum("bhsf,bhsd->bhfd", phi_k, v)
        z  = torch.einsum("bhsf->bhf", phi_k)
        num = torch.einsum("bhqf,bhfd->bhqd", phi_q, kv)
        den = torch.einsum("bhqf,bhf->bhq", phi_q, z)[..., None] + 1e-6
        o = num / den
        return (lambda x, *d: x.permute(*d))(o, 0, 2, 1, 3).reshape(B, S, D) @ wo

    def _B_ref(x, dft_seq_re, dft_seq_im, dft_hid_re, dft_hid_im):
        a = torch.einsum("bsd,ed->bse", x, dft_hid_re)
        b = torch.einsum("bsd,ed->bse", x, dft_hid_im)
        y = torch.einsum("ts,bse->bte", dft_seq_re, a) - torch.einsum("ts,bse->bte", dft_seq_im, b)
        return y

    x = A_x
    x = x + _A_ref(_layernorm(x, axis=-1), A_wqkv, A_w_phi, A_wo)
    x = x + _B_ref(_layernorm(x, axis=-1), B_dft_seq_re, B_dft_seq_im, B_dft_hid_re, B_dft_hid_im)
    x = x + _A_ref(_layernorm(x, axis=-1), A_wqkv, A_w_phi, A_wo)
    x = x + _B_ref(_layernorm(x, axis=-1), B_dft_seq_re, B_dft_seq_im, B_dft_hid_re, B_dft_hid_im)
    return x
```

```asm
; @launch grid=(256,1,1) block=(512,1,1) lds=163840
.amdgcn_target "amdgcn-amd-amdhsa--gfx950"
.text
.globl interleave_layers__linear_kernel_hedgehog__spectral_fnet__prompt_kernel
.p2align 8
.type interleave_layers__linear_kernel_hedgehog__spectral_fnet__prompt_kernel,@function
interleave_layers__linear_kernel_hedgehog__spectral_fnet__prompt_kernel:
    s_cmp_ge_u32 s2, 256
    s_cbranch_scc1 L_end
    s_load_dwordx2 s[12:13], s[0:1], 8
    s_load_dwordx2 s[8:9], s[0:1], 0
    s_load_dwordx4 s[20:23], s[0:1], 16
    s_load_dwordx2 s[34:35], s[0:1], 72
    s_load_dwordx2 s[38:39], s[0:1], 88
    s_lshr_b32 s71, s2, 3
    s_getpc_b64 s[54:55]
    s_lshl_b32 s3, s71, 7
    v_lshl_add_u32 v1, v0, 7, s3
    v_min_u32 v1, L_end-interleave_layers__linear_kernel_hedgehog__spectral_fnet__prompt_kernel-64, v1
    s_mov_b32 exec_lo, 1
    s_mov_b32 exec_hi, 1
    global_load_dword v2, v1, s[54:55]
    s_mov_b64 exec, -1
    v_lshrrev_b32 v1, 6, v0
    s_nop 0
    v_readfirstlane_b32 s69, v1
    s_lshr_b32 s49, s2, 4
    s_and_b32 s45, s2, 7
    s_lshl_b32 s48, s45, 1
    s_and_b32 s3, s71, 1
    s_add_u32 s48, s48, s3
    s_and_b32 s50, s69, 3
    v_and_b32 v0, 63, v0
    v_lshlrev_b32 v1, 4, v0
    s_cmp_lt_u32 s69, 4
    s_cbranch_scc1 L_P0
    s_setprio 3
    v_lshrrev_b32 v60, 2, v0
    v_mul_u32_u24 v60, 2624, v60
    v_add_u32 v60, v60, v1
    s_mov_b32 s14, 1204224
    s_mov_b32 s15, 0x20000
    s_lshl_b32 s62, s71, 2
    s_add_u32 s62, s62, s50
    s_mul_i32 s44, s45, 7
    s_lshr_b32 s3, s62, 4
    s_add_u32 s44, s44, s3
    s_and_b32 s55, s44, 1
    s_lshr_b32 s54, s44, 1
    s_and_b32 s3, s62, 15
    s_mul_i32 s54, s54, 48
    s_add_u32 s54, s54, s55
    s_lshl_b32 s54, s54, 4
    s_add_u32 s54, s54, s3
    s_mul_i32 s57, s54, 56
    s_cmp_ge_u32 s62, 112
    s_cselect_b32 s57, 268435456, s57
    s_waitcnt lgkmcnt(0)
    buffer_load_dwordx4 v[100:103], v60, s[12:15], s57 offen offset:896
    s_load_dword s51, s[38:39], 0
    v_and_b32 v50, 3, v0
    v_and_b32 v42, 7, v0
    v_lshrrev_b32 v46, 5, v0
    s_mov_b32 s43, 0x20000
    s_mov_b64 s[40:41], s[20:21]
    s_mov_b32 s42, 25088
    s_mov_b32 m0, 89600
    s_mul_i32 s54, s49, 1568
    buffer_load_dwordx4 v1, s[40:43], s54 offen lds
    s_mov_b32 exec_hi, 3
    buffer_load_dwordx4 v1, s[40:43], s54 offen offset:1024 lds
    s_mov_b32 exec_hi, -1
    s_lshl_b32 s54, s71, 4
    v_bfe_u32 v48, v0, 4, 1
    v_lshl_add_u32 v47, v48, 3, v42
    v_add_u32 v47, s54, v47
    v_sub_u32 v48, 448, v47
    v_cmp_eq_u32 vcc, 0, v47
    v_mov_b32 v49, 224
    s_nop 0
    v_cndmask_b32 v48, v48, v49, vcc
    s_mov_b32 vcc_lo, 0xff00ff00
    s_mov_b32 vcc_hi, 0xff00ff00
    v_cndmask_b32 v47, v47, v48, vcc
    v_mul_u32_u24 v48, 12544, v46
    v_lshl_add_u32 v94, v47, 1, v48
    v_and_b32 v94, 0xffff, v94
    v_add_u32 v95, 3584, v94
    s_lshl_b32 s37, s45, 2
    s_add_u32 s37, s37, s50
    s_lshr_b32 s55, s37, 1
    s_lshl_b32 s55, s55, 2
    s_and_b32 s3, s50, 1
    s_add_u32 s55, s55, s3
    s_mul_i32 s29, s55, 6272
    s_lshl_b32 s54, s54, 1
    s_add_u32 s37, s37, s54
    s_cmp_ge_u32 s71, 14
    s_cselect_b32 s29, 268435456, s29
    s_cselect_b32 s37, 0x40000, s37
    s_mul_i32 s55, s45, 56
    s_add_u32 s55, s55, s62
    s_sub_u32 s55, s55, 72
    s_and_b32 s3, s55, 15
    s_lshr_b32 s55, s55, 4
    s_mul_i32 s30, s3, 84
    s_add_u32 s30, s30, s55
    s_mul_i32 s3, s3, 56
    s_mul_i32 s55, s55, 43008
    s_add_u32 s27, s55, s3
    s_cmp_lt_u32 s62, 72
    s_cselect_b32 s27, 268435456, s27
    s_cselect_b32 s30, 0x40000, s30
    s_mov_b64 s[40:41], s[22:23]
    s_mov_b32 s42, 401408
    buffer_load_ushort v80, v94, s[40:43], s29 offen offset:0
    buffer_load_short_d16_hi v84, v94, s[40:43], s29 offen offset:896
    buffer_load_ushort v81, v94, s[40:43], s29 offen offset:1792
    buffer_load_short_d16_hi v85, v94, s[40:43], s29 offen offset:2688
    buffer_load_ushort v82, v95, s[40:43], s29 offen offset:0
    buffer_load_short_d16_hi v86, v95, s[40:43], s29 offen offset:896
    buffer_load_ushort v83, v95, s[40:43], s29 offen offset:1792
    buffer_load_dwordx4 v[96:99], v60, s[12:15], s27 offen
    s_branch L_G
L_P0:
    s_and_b32 s54, s50, 1
    s_lshl_b32 s54, s54, 5
    s_add_u32 s55, s48, s54
    s_sub_u32 s56, 64, s55
    s_add_u32 s54, s54, 16
    s_cmp_eq_u32 s48, 0
    s_cselect_b32 s56, s54, s56
    s_cmp_lt_u32 s50, 2
    s_cselect_b32 s60, s55, s56
    v_mov_b64 v[176:177], 0
    v_mov_b64 v[178:179], 0
    v_mov_b64 v[180:181], 0
    v_mov_b64 v[182:183], 0
    v_mov_b64 v[184:185], 0
    v_mov_b64 v[186:187], 0
    s_mov_b32 s10, 1835008
    s_mov_b32 s11, 0x20000
    s_mul_i32 s57, s60, 896
    s_mul_i32 s46, s49, 114688
    s_add_u32 s46, s46, s57
    s_add_u32 s47, s46, 57344
    s_waitcnt lgkmcnt(0)
    s_load_dword s51, s[38:39], 0
    s_lshl_b32 s62, s50, 13
    s_add_u32 s62, s62, 93696
    v_lshrrev_b32 v22, 5, v0
    v_and_b32 v26, 3, v0
    s_mov_b64 s[4:5], s[38:39]
    s_mov_b32 s6, 268435456
    s_mov_b32 s7, 0x20000
    s_lshr_b32 s61, s49, 2
    s_mov_b32 s53, 100000
    s_mul_i32 s54, s48, 393216
    s_add_u32 s54, s54, 10485760
    s_mul_i32 s16, s50, 98304
    s_add_u32 s16, s16, s54
    s_mul_i32 s17, s61, 98304
    s_add_u32 s17, s17, s54
    s_lshr_b32 s3, s50, 1
    s_mul_i32 s18, s3, 98304
    s_add_u32 s18, s18, s54
    s_lshl_b32 s3, s49, 11
    s_add_u32 s22, s3, s16
    s_mov_b32 s66, 0
    s_mov_b32 s67, -1
    s_mov_b32 s68, 0x3f803f80
    s_lshl_b32 s37, s49, 11
    s_add_u32 s37, s37, s16
    v_bfe_u32 v23, v0, 2, 1
    v_mul_u32_u24 v23, 14, v23
    v_bfe_u32 v24, v0, 4, 1
    v_mad_u32_u24 v23, v24, 7, v23
    v_bfe_u32 v24, v0, 3, 1
    v_lshl_add_u32 v24, v24, 2, v26
    v_min_u32 v25, 6, v24
    v_add_u32 v25, v23, v25
    v_add_u32 v17, 91648, v1
    v_cmp_eq_u32 vcc, 7, v24
    s_nop 1
    v_cndmask_b32_e64 v25, v25, 28, vcc
    v_lshrrev_b32 v24, 3, v25
    v_and_b32 v27, 3, v25
    v_lshl_add_u32 v27, v24, 2, v27
    v_bfe_u32 v23, v25, 2, 1
    v_lshlrev_b32 v23, 7, v23
    v_lshl_add_u32 v23, v22, 4, v23
    v_add_lshl_u32 v9, v23, v27, 4
    v_add_u32 v9, 89600, v9
    s_mov_b32 exec_hi, 0xffffff
    buffer_load_dwordx4 v[176:179], v1, s[8:11], s46 offen
    buffer_load_dwordx4 v[180:183], v1, s[8:11], s47 offen
    s_mov_b32 exec_hi, -1
    v_bfe_u32 v24, v0, 2, 2
    v_lshl_add_u32 v23, v22, 3, v24
    v_lshlrev_b32 v23, 6, v23
    v_bfe_u32 v25, v0, 4, 1
    v_lshl_add_u32 v25, v25, 2, v26
    v_lshl_add_u32 v23, v25, 3, v23
    s_lshl_b32 s3, s50, 10
    v_add_u32 v4, s3, v23
    v_xor_b32 v5, 1024, v4
    v_xor_b32 v6, 2048, v4
    v_xor_b32 v7, 3072, v4
    v_and_b32 v25, 31, v0
    s_lshl_b32 s54, s50, 5
    v_mul_u32_u24 v23, 224, v25
    v_lshl_add_u32 v23, v22, 5, v23
    v_add_u32 v8, s62, v23
    v_lshrrev_b32 v16, 1, v25
    v_lshlrev_b32 v16, 7, v16
    v_and_b32 v23, 1, v0
    v_lshl_add_u32 v16, v23, 5, v16
    v_lshl_add_u32 v16, v22, 6, v16
    s_lshl_b32 s44, s48, 2
    s_add_u32 s44, s44, s50
    s_lshl_b32 s44, s44, 11
    s_add_u32 s44, s44, 65536
    s_lshl_b32 s45, s49, 7
    s_add_u32 s45, s45, s44
    v_bfe_u32 v23, v0, 1, 3
    v_xor_b32 v23, v23, v22
    v_lshlrev_b32 v25, 7, v25
    v_lshl_add_u32 v25, v23, 4, v25
    v_xor_b32 v25, s54, v25
    v_add_u32 v18, s62, v25
    v_xor_b32 v19, 32, v18
    v_xor_b32 v20, 64, v18
    v_xor_b32 v21, 96, v18
    v_lshlrev_b32 v10, 4, v22
    v_add_u32 v10, 57600, v10
    v_lshlrev_b32 v30, 2, v0
    v_add_u32 v30, 57728, v30
    s_mov_b32 s10, 1835008
    s_mov_b32 s11, 0x20000
    v_lshrrev_b32 v27, 3, v0
    v_mul_u32_u24 v27, 57216, v27
    v_and_b32 v26, 48, v0
    v_xor_b32 v26, v26, v1
    v_add_u32 v26, v26, v27
    v_xor_b32 v27, 64, v26
    v_add_u32 v28, 915456, v26
    v_add_u32 v29, 1373184, v27
    v_add_u32 v27, 457728, v27
    s_mul_i32 s57, s60, 896
    s_lshl_b32 s62, s50, 13
    s_add_u32 s62, s62, 93696
    s_setprio 2
    s_waitcnt lgkmcnt(0)
    s_barrier
    s_add_u32 s54, s57, 0
    s_add_u32 m0, s62, 0
    s_nop 0
    buffer_load_dwordx4 v26, s[8:11], s54 offen offset:0 lds
    buffer_load_dwordx4 v27, s[8:11], s54 offen offset:1024 lds
    buffer_load_dwordx4 v28, s[8:11], s54 offen offset:2048 lds
    buffer_load_dwordx4 v29, s[8:11], s54 offen offset:3072 lds
    s_add_u32 s54, s57, 128
    s_add_u32 m0, s62, 4096
    s_nop 0
    buffer_load_dwordx4 v26, s[8:11], s54 offen offset:0 lds
    buffer_load_dwordx4 v27, s[8:11], s54 offen offset:1024 lds
    buffer_load_dwordx4 v28, s[8:11], s54 offen offset:2048 lds
    buffer_load_dwordx4 v29, s[8:11], s54 offen offset:3072 lds
    s_waitcnt vmcnt(8)
    s_add_u32 s51, s51, 1
    v_and_b32 v160, 15, v0
    v_mul_u32_u24 v160, 0x2f35, v160
    v_add_u32 v160, s51, v160
    v_and_b32 v161, 0x1fff, v160
    v_and_b32 v160, 0x2000, v160
    v_lshl_or_b32 v160, v160, 2, v161
    v_or_b32 v160, 0x2000, v160
    v_lshlrev_b32 v2, 16, v160
    s_nop 0
    v_readlane_b32 s70, v2, 15
    v_dot2c_f32_bf16 v184, s68, v176
    v_dot2c_f32_bf16 v185, v176, v176
    v_dot2c_f32_bf16 v186, s68, v180
    v_dot2c_f32_bf16 v187, v180, v180
    v_dot2c_f32_bf16 v184, s68, v177
    v_dot2c_f32_bf16 v185, v177, v177
    v_dot2c_f32_bf16 v186, s68, v181
    v_dot2c_f32_bf16 v187, v181, v181
    v_dot2c_f32_bf16 v184, s68, v178
    v_dot2c_f32_bf16 v185, v178, v178
    v_dot2c_f32_bf16 v186, s68, v182
    v_dot2c_f32_bf16 v187, v182, v182
    v_dot2c_f32_bf16 v184, s68, v179
    v_dot2c_f32_bf16 v185, v179, v179
    v_dot2c_f32_bf16 v186, s68, v183
    v_dot2c_f32_bf16 v187, v183, v183
    s_mul_i32 s46, s51, 0x9e3779b1
    v_lshlrev_b32 v178, 1, v0
    v_mov_b32 v177, s46
    v_permlane32_swap_b32 v184, v185
    v_permlane32_swap_b32 v186, v187
    v_add_f32 v184, v184, v185
    v_add_f32 v186, v186, v187
    s_nop 1
    v_permlane16_swap_b32 v184, v186
    v_add_f32 v184, v184, v186
    s_nop 1
    v_add_f32_dpp v184, v184, v184 row_ror:8 row_mask:0xf bank_mask:0xf
    s_nop 1
    v_add_f32_dpp v184, v184, v184 row_ror:4 row_mask:0xf bank_mask:0xf
    s_nop 1
    v_add_f32_dpp v184, v184, v184 row_ror:2 row_mask:0xf bank_mask:0xf
    s_nop 1
    v_add_f32_dpp v176, v184, v184 row_ror:1 row_mask:0xf bank_mask:0xf
    s_branch L_P
L_G:
    s_mov_b64 s[4:5], s[38:39]
    s_mov_b32 s6, 268435456
    s_mov_b32 s7, 0x20000
    s_lshr_b32 s61, s49, 2
    s_mov_b32 s53, 100000
    s_mul_i32 s54, s48, 393216
    s_add_u32 s54, s54, 10485760
    s_mul_i32 s16, s50, 98304
    s_add_u32 s16, s16, s54
    s_mul_i32 s17, s61, 98304
    s_add_u32 s17, s17, s54
    s_lshr_b32 s3, s50, 1
    s_mul_i32 s18, s3, 98304
    s_add_u32 s18, s18, s54
    s_lshl_b32 s3, s49, 11
    s_add_u32 s22, s3, s16
    v_mov_b32 v20, -1
    v_mov_b32 v21, -1
    v_mov_b32 v22, -1
    v_mov_b32 v23, -1
    s_lshl_b32 s46, s50, 10
    v_add_u32 v3, s46, v1
    v_lshrrev_b32 v40, 4, v0
    s_and_b32 s3, s62, 15
    s_mul_i32 s3, s3, 84
    s_and_b32 s55, s44, 1
    s_mul_i32 s55, s55, 28
    s_lshr_b32 s44, s44, 1
    s_add_u32 s44, s44, s3
    s_add_u32 s44, s44, s55
    s_cmp_ge_u32 s62, 112
    s_cselect_b32 s44, 0x40000, s44
    s_lshl_b32 s44, s44, 10
    s_add_u32 s62, s44, 8388608
    s_and_b32 s3, s49, 3
    s_lshl_b32 s3, s3, 2
    s_add_u32 s3, s3, s50
    s_cmp_lt_u32 s3, 14
    s_cselect_b32 s65, 1, 0
    s_min_u32 s64, s3, 13
    s_and_b32 s3, s49, 2
    s_lshl_b32 s3, s3, 1
    s_add_u32 s3, s3, s50
    s_cmp_lt_u32 s3, 7
    s_cselect_b32 s59, 1, 0
    s_min_u32 s58, s3, 6
    s_mul_i32 s36, s48, 14
    s_add_u32 s36, s36, s49
    s_lshl_b32 s36, s36, 13
    s_cmp_ge_u32 s49, 14
    s_cselect_b32 s36, 268435456, s36
    s_mul_i32 s26, s49, 86016
    s_add_u32 s26, s26, 8388608
    s_and_b32 s3, s50, 1
    s_mul_i32 s32, s3, 28672
    s_mul_i32 s33, s3, 28800
    s_and_b32 s3, s46, 2048
    s_add_u32 s32, s32, s3
    s_add_u32 s33, s33, s3
    s_add_u32 s32, s32, s26
    s_add_u32 s26, s26, 57344
    s_lshl_b32 s28, s49, 2
    s_add_u32 s28, s28, s50
    s_lshl_b32 s28, s28, 14
    s_lshl_b32 s3, s48, 8
    s_add_u32 s28, s28, s3
    s_lshl_b32 s19, s64, 10
    s_add_u32 s19, s19, s17
    s_add_u32 s19, s19, 32768
    v_and_b32 v6, 48, v0
    v_mul_u32_u24 v6, 240, v6
    v_add_u32 v6, v6, v1
    v_bfe_u32 v7, v0, 1, 3
    v_mul_u32_u24 v7, 114688, v7
    v_lshl_add_u32 v7, v40, 5, v7
    v_and_b32 v47, 1, v0
    v_lshl_add_u32 v7, v47, 4, v7
    v_lshrrev_b32 v47, 2, v0
    v_mul_u32_u24 v47, 224, v47
    v_lshl_add_u32 v47, v50, 3, v47
    s_and_b32 s3, s50, 1
    s_lshl_b32 s3, s3, 6
    s_add_u32 s3, s3, 93696
    v_add_u32 v4, s3, v47
    s_lshr_b32 s3, s50, 1
    s_lshl_b32 s3, s3, 5
    s_add_u32 s3, s3, 93824
    v_add_u32 v5, s3, v47
    s_lshr_b32 s3, s64, 2
    s_lshl_b32 s3, s3, 10
    s_add_u32 s25, s17, s3
    s_and_b32 s3, s64, 3
    s_lshl_b32 s3, s3, 2
    s_add_u32 s25, s25, s3
    s_add_u32 s25, s25, 61440
    s_and_b32 s54, s61, 1
    s_lshl_b32 s54, s54, 5
    s_add_u32 s55, s48, s54
    s_sub_u32 s56, 64, s55
    s_add_u32 s54, s54, 16
    s_cmp_eq_u32 s48, 0
    s_cselect_b32 s56, s54, s56
    s_cmp_lt_u32 s61, 2
    s_cselect_b32 s63, s55, s56
    s_lshl_b32 s24, s58, 7
    s_add_u32 s24, s24, s63
    s_and_b32 s3, s49, 1
    s_lshl_b32 s3, s3, 6
    s_add_u32 s24, s24, s3
    s_lshl_b32 s24, s24, 7
    s_waitcnt lgkmcnt(0)
    s_bfe_u32 s54, s51, 0x70001
    s_bfe_u32 s55, s51, 0x70008
    s_lshl_b32 s55, s55, 16
    s_or_b32 s55, s54, s55
    s_or_b32 s68, s55, 0x43804300
    v_mov_b32 v92, s68
    s_mov_b32 vcc_lo, 0x88888888
    s_mov_b32 vcc_hi, 0x88888888
    s_waitcnt vmcnt(10)
    v_cndmask_b32 v103, v103, v92, vcc
    v_cndmask_b32_e64 v102, v102, 0, vcc
    buffer_store_dwordx4 v[100:103], v1, s[4:7], s62 offen sc1
    s_barrier
    s_setprio 0
    v_and_b32 v50, 3, v0
    v_bfe_u32 v47, v0, 3, 2
    v_lshl_add_u32 v47, v47, 2, v50
    v_and_b32 v48, 4, v0
    v_lshl_add_u32 v47, v48, 2, v47
    s_lshl_b32 s3, s58, 5
    v_add_u32 v47, s3, v47
    v_mov_b32 v48, 224
    v_cmp_eq_u32 vcc, 0, v47
    s_nop 1
    v_cndmask_b32 v47, v47, v48, vcc
    v_cvt_f32_u32 v47, v47
    v_mul_f32 v52, 0x3b124925, v47
    v_lshrrev_b32 v48, 5, v0
    v_cvt_f32_u32 v48, v48
    v_mul_f32 v48, 4.0, v48
    s_bitcmp1_b32 s49, 0
    s_cselect_b32 s3, 0x3e800000, 0
    s_cselect_b32 vcc_lo, 0, 0xaaaaaaaa
    s_mov_b32 vcc_hi, 0
    v_fma_f32 v53, v48, v52, s3
    v_mul_f32 v54, 0x41800000, v52
    v_cos_f32 v54, v54
    v_mov_b32 v48, 0x3f80
    v_cndmask_b32 v76, 0, v48, vcc
    v_add_f32 v54, v54, v54
    v_mov_b32 v77, 0
    v_mov_b32 v78, 0
    v_mov_b32 v79, 0
    v_fmamk_f32 v36, v52, 0x0, v53
    v_fmamk_f32 v37, v52, 0x3f800000, v53
    v_fmamk_f32 v38, v52, 0x40000000, v53
    v_fmamk_f32 v39, v52, 0x40400000, v53
    v_fmamk_f32 v40, v52, 0x41000000, v53
    v_fmamk_f32 v41, v52, 0x41100000, v53
    v_fmamk_f32 v42, v52, 0x41200000, v53
    v_fmamk_f32 v43, v52, 0x41300000, v53
    v_cos_f32 v36, v36
    v_cos_f32 v37, v37
    v_cos_f32 v38, v38
    v_cos_f32 v39, v39
    v_cos_f32 v40, v40
    v_cos_f32 v41, v41
    v_cos_f32 v42, v42
    v_cos_f32 v43, v43
    v_cvt_pk_bf16_f32 v56, v36, v37
    v_cvt_pk_bf16_f32 v57, v38, v39
    v_cvt_pk_bf16_f32 v58, v40, v41
    v_cvt_pk_bf16_f32 v59, v42, v43
    v_xor_b32 v56, v56, v76
    v_accvgpr_write_b32 a0, v56
    v_accvgpr_write_b32 a1, v57
    v_accvgpr_write_b32 a2, v58
    v_accvgpr_write_b32 a3, v59
    v_fmamk_f32 v44, v52, 0x41800000, v53
    v_fmamk_f32 v45, v52, 0x41880000, v53
    v_fmamk_f32 v46, v52, 0x41900000, v53
    v_fmamk_f32 v47, v52, 0x41980000, v53
    v_fmamk_f32 v48, v52, 0x41c00000, v53
    v_fmamk_f32 v49, v52, 0x41c80000, v53
    v_fmamk_f32 v50, v52, 0x41d00000, v53
    v_fmamk_f32 v51, v52, 0x41d80000, v53
    v_cos_f32 v44, v44
    v_cos_f32 v45, v45
    v_cos_f32 v46, v46
    v_cos_f32 v47, v47
    v_cos_f32 v48, v48
    v_cos_f32 v49, v49
    v_cos_f32 v50, v50
    v_cos_f32 v51, v51
    v_cvt_pk_bf16_f32 v56, v44, v45
    v_cvt_pk_bf16_f32 v57, v46, v47
    v_cvt_pk_bf16_f32 v58, v48, v49
    v_cvt_pk_bf16_f32 v59, v50, v51
    v_accvgpr_write_b32 a4, v56
    v_accvgpr_write_b32 a5, v57
    v_accvgpr_write_b32 a6, v58
    v_accvgpr_write_b32 a7, v59
    v_fma_f32 v36, v44, v54, -v36
    v_fma_f32 v37, v45, v54, -v37
    v_fma_f32 v38, v46, v54, -v38
    v_fma_f32 v39, v47, v54, -v39
    v_fma_f32 v40, v48, v54, -v40
    v_fma_f32 v41, v49, v54, -v41
    v_fma_f32 v42, v50, v54, -v42
    v_fma_f32 v43, v51, v54, -v43
    v_cvt_pk_bf16_f32 v56, v36, v37
    v_cvt_pk_bf16_f32 v57, v38, v39
    v_cvt_pk_bf16_f32 v58, v40, v41
    v_cvt_pk_bf16_f32 v59, v42, v43
    v_accvgpr_write_b32 a8, v56
    v_accvgpr_write_b32 a9, v57
    v_accvgpr_write_b32 a10, v58
    v_accvgpr_write_b32 a11, v59
    v_fma_f32 v44, v36, v54, -v44
    v_fma_f32 v45, v37, v54, -v45
    v_fma_f32 v46, v38, v54, -v46
    v_fma_f32 v47, v39, v54, -v47
    v_fma_f32 v48, v40, v54, -v48
    v_fma_f32 v49, v41, v54, -v49
    v_fma_f32 v50, v42, v54, -v50
    v_fma_f32 v51, v43, v54, -v51
    v_cvt_pk_bf16_f32 v56, v44, v45
    v_cvt_pk_bf16_f32 v57, v46, v47
    v_cvt_pk_bf16_f32 v58, v48, v49
    v_cvt_pk_bf16_f32 v59, v50, v51
    v_accvgpr_write_b32 a12, v56
    v_accvgpr_write_b32 a13, v57
    v_accvgpr_write_b32 a14, v58
    v_accvgpr_write_b32 a15, v59
    v_fma_f32 v36, v44, v54, -v36
    v_fma_f32 v37, v45, v54, -v37
    v_fma_f32 v38, v46, v54, -v38
    v_fma_f32 v39, v47, v54, -v39
    v_fma_f32 v40, v48, v54, -v40
    v_fma_f32 v41, v49, v54, -v41
    v_fma_f32 v42, v50, v54, -v42
    v_fma_f32 v43, v51, v54, -v43
    v_cvt_pk_bf16_f32 v56, v36, v37
    v_cvt_pk_bf16_f32 v57, v38, v39
    v_cvt_pk_bf16_f32 v58, v40, v41
    v_cvt_pk_bf16_f32 v59, v42, v43
    v_accvgpr_write_b32 a16, v56
    v_accvgpr_write_b32 a17, v57
    v_accvgpr_write_b32 a18, v58
    v_accvgpr_write_b32 a19, v59
    v_fma_f32 v44, v36, v54, -v44
    v_fma_f32 v45, v37, v54, -v45
    v_fma_f32 v46, v38, v54, -v46
    v_fma_f32 v47, v39, v54, -v47
    v_fma_f32 v48, v40, v54, -v48
    v_fma_f32 v49, v41, v54, -v49
    v_fma_f32 v50, v42, v54, -v50
    v_fma_f32 v51, v43, v54, -v51
    v_cvt_pk_bf16_f32 v56, v44, v45
    v_cvt_pk_bf16_f32 v57, v46, v47
    v_cvt_pk_bf16_f32 v58, v48, v49
    v_cvt_pk_bf16_f32 v59, v50, v51
    v_accvgpr_write_b32 a20, v56
    v_accvgpr_write_b32 a21, v57
    v_accvgpr_write_b32 a22, v58
    v_accvgpr_write_b32 a23, v59
    v_fma_f32 v36, v44, v54, -v36
    v_fma_f32 v37, v45, v54, -v37
    v_fma_f32 v38, v46, v54, -v38
    v_fma_f32 v39, v47, v54, -v39
    v_fma_f32 v40, v48, v54, -v40
    v_fma_f32 v41, v49, v54, -v41
    v_fma_f32 v42, v50, v54, -v42
    v_fma_f32 v43, v51, v54, -v43
    v_cvt_pk_bf16_f32 v56, v36, v37
    v_cvt_pk_bf16_f32 v57, v38, v39
    v_cvt_pk_bf16_f32 v58, v40, v41
    v_cvt_pk_bf16_f32 v59, v42, v43
    v_accvgpr_write_b32 a24, v56
    v_accvgpr_write_b32 a25, v57
    v_accvgpr_write_b32 a26, v58
    v_accvgpr_write_b32 a27, v59
    v_fma_f32 v44, v36, v54, -v44
    v_fma_f32 v45, v37, v54, -v45
    v_fma_f32 v46, v38, v54, -v46
    v_fma_f32 v47, v39, v54, -v47
    v_fma_f32 v48, v40, v54, -v48
    v_fma_f32 v49, v41, v54, -v49
    v_fma_f32 v50, v42, v54, -v50
    v_fma_f32 v51, v43, v54, -v51
    v_cvt_pk_bf16_f32 v56, v44, v45
    v_cvt_pk_bf16_f32 v57, v46, v47
    v_cvt_pk_bf16_f32 v58, v48, v49
    v_cvt_pk_bf16_f32 v59, v50, v51
    v_accvgpr_write_b32 a28, v56
    v_accvgpr_write_b32 a29, v57
    v_accvgpr_write_b32 a30, v58
    v_accvgpr_write_b32 a31, v59
    v_fma_f32 v36, v44, v54, -v36
    v_fma_f32 v37, v45, v54, -v37
    v_fma_f32 v38, v46, v54, -v38
    v_fma_f32 v39, v47, v54, -v39
    v_fma_f32 v40, v48, v54, -v40
    v_fma_f32 v41, v49, v54, -v41
    v_fma_f32 v42, v50, v54, -v42
    v_fma_f32 v43, v51, v54, -v43
    v_cvt_pk_bf16_f32 v56, v36, v37
    v_cvt_pk_bf16_f32 v57, v38, v39
    v_cvt_pk_bf16_f32 v58, v40, v41
    v_cvt_pk_bf16_f32 v59, v42, v43
    v_accvgpr_write_b32 a32, v56
    v_accvgpr_write_b32 a33, v57
    v_accvgpr_write_b32 a34, v58
    v_accvgpr_write_b32 a35, v59
    v_fma_f32 v44, v36, v54, -v44
    v_fma_f32 v45, v37, v54, -v45
    v_fma_f32 v46, v38, v54, -v46
    v_fma_f32 v47, v39, v54, -v47
    v_fma_f32 v48, v40, v54, -v48
    v_fma_f32 v49, v41, v54, -v49
    v_fma_f32 v50, v42, v54, -v50
    v_fma_f32 v51, v43, v54, -v51
    v_cvt_pk_bf16_f32 v56, v44, v45
    v_cvt_pk_bf16_f32 v57, v46, v47
    v_cvt_pk_bf16_f32 v58, v48, v49
    v_cvt_pk_bf16_f32 v59, v50, v51
    v_accvgpr_write_b32 a36, v56
    v_accvgpr_write_b32 a37, v57
    v_accvgpr_write_b32 a38, v58
    v_accvgpr_write_b32 a39, v59
    v_fma_f32 v36, v44, v54, -v36
    v_fma_f32 v37, v45, v54, -v37
    v_fma_f32 v38, v46, v54, -v38
    v_fma_f32 v39, v47, v54, -v39
    v_fma_f32 v40, v48, v54, -v40
    v_fma_f32 v41, v49, v54, -v41
    v_fma_f32 v42, v50, v54, -v42
    v_fma_f32 v43, v51, v54, -v43
    v_cvt_pk_bf16_f32 v56, v36, v37
    v_cvt_pk_bf16_f32 v57, v38, v39
    v_cvt_pk_bf16_f32 v58, v40, v41
    v_cvt_pk_bf16_f32 v59, v42, v43
    v_accvgpr_write_b32 a40, v56
    v_accvgpr_write_b32 a41, v57
    v_accvgpr_write_b32 a42, v58
    v_accvgpr_write_b32 a43, v59
    v_fma_f32 v44, v36, v54, -v44
    v_fma_f32 v45, v37, v54, -v45
    v_fma_f32 v46, v38, v54, -v46
    v_fma_f32 v47, v39, v54, -v47
    v_fma_f32 v48, v40, v54, -v48
    v_fma_f32 v49, v41, v54, -v49
    v_fma_f32 v50, v42, v54, -v50
    v_fma_f32 v51, v43, v54, -v51
    v_cvt_pk_bf16_f32 v56, v44, v45
    v_cvt_pk_bf16_f32 v57, v46, v47
    v_cvt_pk_bf16_f32 v58, v48, v49
    v_cvt_pk_bf16_f32 v59, v50, v51
    v_accvgpr_write_b32 a44, v56
    v_accvgpr_write_b32 a45, v57
    v_accvgpr_write_b32 a46, v58
    v_accvgpr_write_b32 a47, v59
    v_fma_f32 v36, v44, v54, -v36
    v_fma_f32 v37, v45, v54, -v37
    v_fma_f32 v38, v46, v54, -v38
    v_fma_f32 v39, v47, v54, -v39
    v_fma_f32 v40, v48, v54, -v40
    v_fma_f32 v41, v49, v54, -v41
    v_fma_f32 v42, v50, v54, -v42
    v_fma_f32 v43, v51, v54, -v43
    v_cvt_pk_bf16_f32 v68, v36, v37
    v_cvt_pk_bf16_f32 v69, v38, v39
    v_cvt_pk_bf16_f32 v70, v40, v41
    v_cvt_pk_bf16_f32 v71, v42, v43
    v_fma_f32 v44, v36, v54, -v44
    v_fma_f32 v45, v37, v54, -v45
    v_fma_f32 v46, v38, v54, -v46
    v_fma_f32 v47, v39, v54, -v47
    v_fma_f32 v48, v40, v54, -v48
    v_fma_f32 v49, v41, v54, -v49
    v_fma_f32 v50, v42, v54, -v50
    v_fma_f32 v51, v43, v54, -v51
    v_cvt_pk_bf16_f32 v72, v44, v45
    v_cvt_pk_bf16_f32 v73, v46, v47
    v_cvt_pk_bf16_f32 v74, v48, v49
    v_cvt_pk_bf16_f32 v75, v50, v51
    s_setprio 3
    s_add_u32 s51, s51, 1
    v_and_b32 v36, 15, v0
    v_mul_u32_u24 v36, 0x2f35, v36
    v_add_u32 v36, s51, v36
    v_and_b32 v37, 0x1fff, v36
    v_and_b32 v36, 0x2000, v36
    v_lshl_or_b32 v36, v36, 2, v37
    v_or_b32 v36, 0x2000, v36
    v_lshlrev_b32 v2, 16, v36
    s_nop 0
    v_readlane_b32 s70, v2, 15
    s_lshl_b32 s54, s68, 16
    s_and_b32 s55, s68, 0xffff0000
    v_mov_b32 v36, s54
    v_writelane_b32 v36, s55, 31
    v_lshrrev_b32 v44, 5, v0
    v_bfe_u32 v45, v0, 2, 2
    v_lshl_add_u32 v44, v44, 3, v45
    v_lshlrev_b32 v44, 6, v44
    v_bfe_u32 v45, v0, 4, 1
    v_lshl_add_u32 v44, v45, 5, v44
    v_and_b32 v45, 3, v0
    v_lshl_add_u32 v44, v45, 3, v44
    s_add_u32 s3, s46, 60672
    v_add_u32 v46, s3, v44
    v_add_u32 v44, s33, v44
    s_lshl_b32 s3, s50, 7
    s_add_u32 s3, s3, 59648
    v_lshl_add_u32 v45, v0, 2, s3
    s_mov_b32 vcc_lo, 0xf0f00f0f
    s_mov_b32 vcc_hi, 0xf0f00f0f
    v_mov_b32 v48, 0x3f803f80
    v_cndmask_b32 v48, 0, v48, vcc
    v_mov_b32 v49, v48
    v_mov_b32 v50, v48
    v_mov_b32 v51, v48
    s_mov_b32 vcc_lo, 0x88888888
    s_mov_b32 vcc_hi, 0x88888888
    s_lshl_b32 s30, s30, 10
    s_add_u32 s30, s30, 8445952
    s_lshl_b32 s37, s37, 10
    s_add_u32 s37, s37, 262144
    v_and_b32 v87, 0x87ff0000, v2
    v_or_b32 v87, 0x08000000, v87
    s_getreg_b32 s3, hwreg(HW_REG_XCC_ID, 0, 4)
    s_mul_i32 s54, s51, 0x9e3779b1
    v_mov_b32 v88, s54
    v_mov_b32 v89, s3
    s_lshl_b32 s56, s48, 4
    s_add_u32 s56, s56, s49
    s_lshl_b32 s56, s56, 7
    s_add_u32 s56, s56, 4096
    s_lshl_b32 s3, s50, 28
    s_add_u32 s56, s56, s3
    s_waitcnt vmcnt(1)
    s_add_u32 s44, s32, 0
    s_add_u32 m0, s33, 0
    s_nop 0
    buffer_load_dwordx4 v1, s[4:7], s44 offen sc1 lds
    buffer_load_dwordx4 v1, s[4:7], s44 offen offset:1024 sc1 lds
    s_add_u32 s44, s32, 4096
    s_add_u32 m0, s33, 4096
    s_nop 0
    buffer_load_dwordx4 v1, s[4:7], s44 offen sc1 lds
    buffer_load_dwordx4 v1, s[4:7], s44 offen offset:1024 sc1 lds
    s_waitcnt vmcnt(5)
    s_mov_b32 vcc_lo, 0x88888888
    s_mov_b32 vcc_hi, 0x88888888
    v_cndmask_b32 v99, v99, v92, vcc
    v_cndmask_b32_e64 v98, v98, 0, vcc
    v_xor_b32 v80, v80, v84
    v_xor_b32 v81, v81, v85
    v_xor_b32 v82, v82, v86
    v_xor_b32 v83, v83, v87
    buffer_store_dwordx4 v[96:99], v1, s[4:7], s30 offen sc1
    buffer_store_dwordx4 v[80:83], v1, s[4:7], s37 offen sc1
    s_mov_b64 exec, 0xff
    buffer_store_dwordx4 v[88:91], v1, s[4:7], s56 offen sc1
    s_mov_b64 exec, -1
    s_add_u32 s44, s32, 8192
    s_add_u32 m0, s33, 8192
    s_nop 0
    buffer_load_dwordx4 v1, s[4:7], s44 offen sc1 lds
    buffer_load_dwordx4 v1, s[4:7], s44 offen offset:1024 sc1 lds
    s_add_u32 s44, s32, 12288
    s_add_u32 m0, s33, 12288
    s_nop 0
    buffer_load_dwordx4 v1, s[4:7], s44 offen sc1 lds
    buffer_load_dwordx4 v1, s[4:7], s44 offen offset:1024 sc1 lds
    s_waitcnt vmcnt(7)
    ds_read_b64_tr_b16 v[176:177], v44 offset:0
    ds_read_b64_tr_b16 v[178:179], v44 offset:256
    ds_read_b64_tr_b16 v[180:181], v44 offset:1024
    ds_read_b64_tr_b16 v[182:183], v44 offset:1280
    ds_read_b64_tr_b16 v[184:185], v44 offset:4096
    ds_read_b64_tr_b16 v[186:187], v44 offset:4352
    ds_read_b64_tr_b16 v[188:189], v44 offset:5120
    ds_read_b64_tr_b16 v[190:191], v44 offset:5376
    v_mul_f32 v37, 0x42800000, v36
    s_waitcnt lgkmcnt(4)
    v_mfma_f32_16x16x32_bf16 v[52:55], v[48:51], v[176:179], 0
    v_mfma_f32_16x16x32_bf16 v[52:55], v[48:51], v[180:183], v[52:55]
    s_waitcnt lgkmcnt(0)
    v_mfma_f32_16x16x32_bf16 v[52:55], v[48:51], v[184:187], v[52:55]
    v_mfma_f32_16x16x32_bf16 v[52:55], v[48:51], v[188:191], v[52:55]
    s_nop 7
    v_cmp_neq_f32 vcc, v52, v37
    s_nop 0
    s_and_b64 vcc, vcc, 0xc0000000
    s_cbranch_vccz L_rg_2
L_rt_1:
    s_add_u32 s44, s32, 0
    s_add_u32 m0, s33, 0
    s_nop 0
    buffer_load_dwordx4 v1, s[4:7], s44 offen sc1 lds
    buffer_load_dwordx4 v1, s[4:7], s44 offen offset:1024 sc1 lds
    s_add_u32 s44, s32, 4096
    s_add_u32 m0, s33, 4096
    s_nop 0
    buffer_load_dwordx4 v1, s[4:7], s44 offen sc1 lds
    buffer_load_dwordx4 v1, s[4:7], s44 offen offset:1024 sc1 lds
    s_waitcnt vmcnt(0)
    ds_read_b64_tr_b16 v[176:177], v44 offset:0
    ds_read_b64_tr_b16 v[178:179], v44 offset:256
    ds_read_b64_tr_b16 v[180:181], v44 offset:1024
    ds_read_b64_tr_b16 v[182:183], v44 offset:1280
    ds_read_b64_tr_b16 v[184:185], v44 offset:4096
    ds_read_b64_tr_b16 v[186:187], v44 offset:4352
    ds_read_b64_tr_b16 v[188:189], v44 offset:5120
    ds_read_b64_tr_b16 v[190:191], v44 offset:5376
    v_mul_f32 v37, 0x42800000, v36
    s_waitcnt lgkmcnt(4)
    v_mfma_f32_16x16x32_bf16 v[52:55], v[48:51], v[176:179], 0
    v_mfma_f32_16x16x32_bf16 v[52:55], v[48:51], v[180:183], v[52:55]
    s_waitcnt lgkmcnt(0)
    v_mfma_f32_16x16x32_bf16 v[52:55], v[48:51], v[184:187], v[52:55]
    v_mfma_f32_16x16x32_bf16 v[52:55], v[48:51], v[188:191], v[52:55]
    s_nop 7
    v_cmp_neq_f32 vcc, v52, v37
    s_nop 0
    s_and_b64 vcc, vcc, 0xc0000000
    s_cbranch_vccz L_ok_3
    s_cmp_eq_u32 s53, 0
    s_cbranch_scc1 L_ok_3
    s_sub_u32 s53, s53, 1
    s_branch L_rt_1
L_ok_3:
L_rg_2:
    s_barrier
    s_add_u32 s44, s32, 16384
    s_add_u32 m0, s33, 16384
    s_nop 0
    buffer_load_dwordx4 v1, s[4:7], s44 offen sc1 lds
    buffer_load_dwordx4 v1, s[4:7], s44 offen offset:1024 sc1 lds
    s_add_u32 s44, s32, 20480
    s_add_u32 m0, s33, 20480
    s_nop 0
    buffer_load_dwordx4 v1, s[4:7], s44 offen sc1 lds
    buffer_load_dwordx4 v1, s[4:7], s44 offen offset:1024 sc1 lds
    s_add_u32 s44, s32, 24576
    s_add_u32 m0, s33, 24576
    s_nop 0
    buffer_load_dwordx4 v1, s[4:7], s44 offen sc1 lds
    buffer_load_dwordx4 v1, s[4:7], s44 offen offset:1024 sc1 lds
    s_waitcnt vmcnt(6)
    ds_read_b64_tr_b16 v[176:177], v44 offset:8192
    ds_read_b64_tr_b16 v[178:179], v44 offset:8448
    ds_read_b64_tr_b16 v[180:181], v44 offset:9216
    ds_read_b64_tr_b16 v[182:183], v44 offset:9472
    ds_read_b64_tr_b16 v[184:185], v44 offset:12288
    ds_read_b64_tr_b16 v[186:187], v44 offset:12544
    ds_read_b64_tr_b16 v[188:189], v44 offset:13312
    ds_read_b64_tr_b16 v[190:191], v44 offset:13568
    v_mul_f32 v37, 0x42800000, v36
    s_waitcnt lgkmcnt(4)
    v_mfma_f32_16x16x32_bf16 v[56:59], v[48:51], v[176:179], 0
    v_mfma_f32_16x16x32_bf16 v[56:59], v[48:51], v[180:183], v[56:59]
    s_waitcnt lgkmcnt(0)
    v_mfma_f32_16x16x32_bf16 v[56:59], v[48:51], v[184:187], v[56:59]
    v_mfma_f32_16x16x32_bf16 v[56:59], v[48:51], v[188:191], v[56:59]
    s_nop 7
    v_cmp_neq_f32 vcc, v56, v37
    s_nop 0
    s_and_b64 vcc, vcc, 0xc0000000
    s_cbranch_vccz L_rg_5
L_rt_4:
    s_add_u32 s44, s32, 8192
    s_add_u32 m0, s33, 8192
    s_nop 0
    buffer_load_dwordx4 v1, s[4:7], s44 offen sc1 lds
    buffer_load_dwordx4 v1, s[4:7], s44 offen offset:1024 sc1 lds
    s_add_u32 s44, s32, 12288
    s_add_u32 m0, s33, 12288
    s_nop 0
    buffer_load_dwordx4 v1, s[4:7], s44 offen sc1 lds
    buffer_load_dwordx4 v1, s[4:7], s44 offen offset:1024 sc1 lds
    s_waitcnt vmcnt(0)
    ds_read_b64_tr_b16 v[176:177], v44 offset:8192
    ds_read_b64_tr_b16 v[178:179], v44 offset:8448
    ds_read_b64_tr_b16 v[180:181], v44 offset:9216
    ds_read_b64_tr_b16 v[182:183], v44 offset:9472
    ds_read_b64_tr_b16 v[184:185], v44 offset:12288
    ds_read_b64_tr_b16 v[186:187], v44 offset:12544
    ds_read_b64_tr_b16 v[188:189], v44 offset:13312
    ds_read_b64_tr_b16 v[190:191], v44 offset:13568
    v_mul_f32 v37, 0x42800000, v36
    s_waitcnt lgkmcnt(4)
    v_mfma_f32_16x16x32_bf16 v[56:59], v[48:51], v[176:179], 0
    v_mfma_f32_16x16x32_bf16 v[56:59], v[48:51], v[180:183], v[56:59]
    s_waitcnt lgkmcnt(0)
    v_mfma_f32_16x16x32_bf16 v[56:59], v[48:51], v[184:187], v[56:59]
    v_mfma_f32_16x16x32_bf16 v[56:59], v[48:51], v[188:191], v[56:59]
    s_nop 7
    v_cmp_neq_f32 vcc, v56, v37
    s_nop 0
    s_and_b64 vcc, vcc, 0xc0000000
    s_cbranch_vccz L_ok_6
    s_cmp_eq_u32 s53, 0
    s_cbranch_scc1 L_ok_6
    s_sub_u32 s53, s53, 1
    s_branch L_rt_4
L_ok_6:
L_rg_5:
    v_add_f32 v52, v52, v56
    s_barrier
    v_bfe_u32 v128, v0, 2, 1
    v_mul_u32_u24 v128, 14, v128
    v_bfe_u32 v129, v0, 4, 1
    v_mad_u32_u24 v128, v129, 7, v128
    v_bfe_u32 v129, v0, 3, 1
    v_and_b32 v130, 3, v0
    v_lshl_add_u32 v129, v129, 2, v130
    v_min_u32 v129, 6, v129
    v_lshrrev_b32 v130, 5, v0
    v_mul_u32_u24 v130, 112, v130
    v_add3_u32 v128, v128, v129, v130
    v_lshlrev_b32 v128, 1, v128
    v_add_u32 v128, 89600, v128
    v_add_u32 v129, 91648, v1
    ds_read_u16 v112, v128 offset:0
    ds_read_u16 v113, v128 offset:56
    ds_read_u16 v114, v128 offset:112
    ds_read_u16 v115, v128 offset:168
    ds_read_u16 v116, v128 offset:448
    ds_read_u16 v117, v128 offset:504
    ds_read_u16 v118, v128 offset:560
    ds_read_u16 v119, v128 offset:616
    ds_read_u16 v120, v128 offset:896
    ds_read_u16 v121, v128 offset:952
    ds_read_u16 v122, v128 offset:1008
    ds_read_u16 v123, v128 offset:1064
    ds_read_u16 v124, v128 offset:1344
    ds_read_u16 v125, v128 offset:1400
    ds_read_u16 v126, v128 offset:1456
    ds_read_u16 v127, v128 offset:1512
    s_waitcnt lgkmcnt(0)
    v_lshl_or_b32 v132, v113, 16, v112
    v_lshl_or_b32 v133, v115, 16, v114
    v_lshl_or_b32 v134, v117, 16, v116
    v_lshl_or_b32 v135, v119, 16, v118
    v_lshl_or_b32 v136, v121, 16, v120
    v_lshl_or_b32 v137, v123, 16, v122
    v_lshl_or_b32 v138, v125, 16, v124
    v_lshl_or_b32 v139, v127, 16, v126
    s_mov_b32 exec_lo, 0
    v_mov_b32 v138, 0
    v_mov_b32 v139, 0
    s_mov_b32 exec_lo, -1
    ds_write_b128 v129, v[132:135]
    ds_write_b128 v129, v[136:139] offset:1024
    s_waitcnt vmcnt(0)
    ds_read_b64_tr_b16 v[176:177], v44 offset:16384
    ds_read_b64_tr_b16 v[178:179], v44 offset:16640
    ds_read_b64_tr_b16 v[180:181], v44 offset:17408
    ds_read_b64_tr_b16 v[182:183], v44 offset:17664
    ds_read_b64_tr_b16 v[184:185], v44 offset:20480
    ds_read_b64_tr_b16 v[186:187], v44 offset:20736
    ds_read_b64_tr_b16 v[188:189], v44 offset:21504
    ds_read_b64_tr_b16 v[190:191], v44 offset:21760
    ds_read_b64_tr_b16 v[192:193], v44 offset:24576
    ds_read_b64_tr_b16 v[194:195], v44 offset:24832
    ds_read_b64_tr_b16 v[196:197], v44 offset:25600
    ds_read_b64_tr_b16 v[198:199], v44 offset:25856
    v_mul_f32 v37, 0x42c00000, v36
    s_waitcnt lgkmcnt(8)
    v_mfma_f32_16x16x32_bf16 v[56:59], v[48:51], v[176:179], 0
    v_mfma_f32_16x16x32_bf16 v[56:59], v[48:51], v[180:183], v[56:59]
    s_waitcnt lgkmcnt(4)
    v_mfma_f32_16x16x32_bf16 v[56:59], v[48:51], v[184:187], v[56:59]
    v_mfma_f32_16x16x32_bf16 v[56:59], v[48:51], v[188:191], v[56:59]
    s_waitcnt lgkmcnt(0)
    v_mfma_f32_16x16x32_bf16 v[56:59], v[48:51], v[192:195], v[56:59]
    v_mfma_f32_16x16x32_bf16 v[56:59], v[48:51], v[196:199], v[56:59]
    s_nop 7
    v_cmp_neq_f32 vcc, v56, v37
    s_nop 0
    s_and_b64 vcc, vcc, 0xc0000000
    s_cbranch_vccz L_rg_8
L_rt_7:
    s_add_u32 s44, s32, 16384
    s_add_u32 m0, s33, 16384
    s_nop 0
    buffer_load_dwordx4 v1, s[4:7], s44 offen sc1 lds
    buffer_load_dwordx4 v1, s[4:7], s44 offen offset:1024 sc1 lds
    s_add_u32 s44, s32, 20480
    s_add_u32 m0, s33, 20480
    s_nop 0
    buffer_load_dwordx4 v1, s[4:7], s44 offen sc1 lds
    buffer_load_dwordx4 v1, s[4:7], s44 offen offset:1024 sc1 lds
    s_add_u32 s44, s32, 24576
    s_add_u32 m0, s33, 24576
    s_nop 0
    buffer_load_dwordx4 v1, s[4:7], s44 offen sc1 lds
    buffer_load_dwordx4 v1, s[4:7], s44 offen offset:1024 sc1 lds
    s_waitcnt vmcnt(0)
    ds_read_b64_tr_b16 v[176:177], v44 offset:16384
    ds_read_b64_tr_b16 v[178:179], v44 offset:16640
    ds_read_b64_tr_b16 v[180:181], v44 offset:17408
    ds_read_b64_tr_b16 v[182:183], v44 offset:17664
    ds_read_b64_tr_b16 v[184:185], v44 offset:20480
    ds_read_b64_tr_b16 v[186:187], v44 offset:20736
    ds_read_b64_tr_b16 v[188:189], v44 offset:21504
    ds_read_b64_tr_b16 v[190:191], v44 offset:21760
    ds_read_b64_tr_b16 v[192:193], v44 offset:24576
    ds_read_b64_tr_b16 v[194:195], v44 offset:24832
    ds_read_b64_tr_b16 v[196:197], v44 offset:25600
    ds_read_b64_tr_b16 v[198:199], v44 offset:25856
    v_mul_f32 v37, 0x42c00000, v36
    s_waitcnt lgkmcnt(8)
    v_mfma_f32_16x16x32_bf16 v[56:59], v[48:51], v[176:179], 0
    v_mfma_f32_16x16x32_bf16 v[56:59], v[48:51], v[180:183], v[56:59]
    s_waitcnt lgkmcnt(4)
    v_mfma_f32_16x16x32_bf16 v[56:59], v[48:51], v[184:187], v[56:59]
    v_mfma_f32_16x16x32_bf16 v[56:59], v[48:51], v[188:191], v[56:59]
    s_waitcnt lgkmcnt(0)
    v_mfma_f32_16x16x32_bf16 v[56:59], v[48:51], v[192:195], v[56:59]
    v_mfma_f32_16x16x32_bf16 v[56:59], v[48:51], v[196:199], v[56:59]
    s_nop 7
    v_cmp_neq_f32 vcc, v56, v37
    s_nop 0
    s_and_b64 vcc, vcc, 0xc0000000
    s_cbranch_vccz L_ok_9
    s_cmp_eq_u32 s53, 0
    s_cbranch_scc1 L_ok_9
    s_sub_u32 s53, s53, 1
    s_branch L_rt_7
L_ok_9:
L_rg_8:
    v_add_f32 v52, v52, v56
    s_mov_b32 exec_hi, 0
    ds_write_b32 v45, v52
    s_mov_b32 exec_hi, -1
    s_waitcnt lgkmcnt(0)
    s_barrier
    s_setprio 0
    s_add_u32 s44, s26, 0
    s_add_u32 m0, s46, 60672
    s_nop 0
    buffer_load_dwordx4 v3, s[4:7], s44 offen sc1 lds
    s_add_u32 s44, s26, 4096
    s_add_u32 m0, s46, 64768
    s_nop 0
    buffer_load_dwordx4 v3, s[4:7], s44 offen sc1 lds
    s_add_u32 s44, s26, 8192
    s_add_u32 m0, s46, 68864
    s_nop 0
    buffer_load_dwordx4 v3, s[4:7], s44 offen sc1 lds
    s_add_u32 s44, s26, 12288
    s_add_u32 m0, s46, 72960
    s_nop 0
    buffer_load_dwordx4 v3, s[4:7], s44 offen sc1 lds
    s_add_u32 s44, s26, 16384
    s_add_u32 m0, s46, 77056
    s_nop 0
    buffer_load_dwordx4 v3, s[4:7], s44 offen sc1 lds
    s_add_u32 s44, s26, 20480
    s_add_u32 m0, s46, 81152
    s_nop 0
    buffer_load_dwordx4 v3, s[4:7], s44 offen sc1 lds
    s_add_u32 s44, s26, 24576
    s_add_u32 m0, s46, 85248
    s_nop 0
    buffer_load_dwordx4 v3, s[4:7], s44 offen sc1 lds
    v_mov_b32 v204, v36
    v_mov_b32 v205, v46
    s_lshl_b32 s3, s48, 11
    s_add_u32 s3, s3, 4096
    v_and_b32 v38, 15, v0
    v_lshlrev_b32 v38, 7, v38
    buffer_load_dwordx2 v[206:207], v38, s[4:7], s3 offen sc1
    s_add_u32 s44, s36, 4194304
    buffer_store_dwordx4 v[20:23], v3, s[4:7], s44 offen sc1
    s_add_u32 s44, s36, 4198400
    buffer_store_dwordx4 v[20:23], v3, s[4:7], s44 offen sc1
    s_add_u32 s44, s28, 2097152
    buffer_store_dwordx4 v[20:23], v6, s[4:7], s44 offen sc1
    s_lshl_b32 s44, s49, 4
    s_add_u32 s44, s44, s48
    s_lshl_b32 s44, s44, 8
    s_lshl_b32 s3, s50, 28
    s_add_u32 s44, s44, s3
    s_add_u32 s44, s44, 1835008
    s_mov_b64 exec, 0xffff
    buffer_store_dwordx4 v[20:23], v1, s[4:7], s44 offen sc1
    s_mov_b64 exec, -1
    s_add_u32 s3, s22, 0
    buffer_store_dwordx4 v[20:23], v1, s[4:7], s3 offen sc1
    buffer_store_dwordx4 v[20:23], v1, s[4:7], s3 offen offset:1024 sc1
    s_add_u32 s3, s22, 32768
    buffer_store_dwordx4 v[20:23], v1, s[4:7], s3 offen sc1
    buffer_store_dwordx4 v[20:23], v1, s[4:7], s3 offen offset:1024 sc1
    s_lshl_b32 s47, s64, 15
    s_add_u32 s47, s47, 262144
    buffer_load_dwordx4 v[80:83], v1, s[4:7], s47 offen offset:0 sc1
    buffer_load_dwordx4 v[84:87], v1, s[4:7], s47 offen offset:1024 sc1
    s_setprio 1
    s_mov_b32 s56, 0xffff
    s_add_u32 s54, s28, 2097152
    s_barrier
    ds_read_b64_tr_b16 v[20:21], v5 offset:0
    ds_read_b64_tr_b16 v[24:25], v4 offset:0
    ds_read_b64_tr_b16 v[28:29], v4 offset:32
    ds_read_b64_tr_b16 v[22:23], v5 offset:3584
    ds_read_b64_tr_b16 v[26:27], v4 offset:3584
    ds_read_b64_tr_b16 v[30:31], v4 offset:3616
    ds_read_b64_tr_b16 v[32:33], v5 offset:8192
    ds_read_b64_tr_b16 v[36:37], v4 offset:8192
    ds_read_b64_tr_b16 v[40:41], v4 offset:8224
    ds_read_b64_tr_b16 v[34:35], v5 offset:11776
    ds_read_b64_tr_b16 v[38:39], v4 offset:11776
    ds_read_b64_tr_b16 v[42:43], v4 offset:11808
    ds_read_b64_tr_b16 v[44:45], v5 offset:16384
    ds_read_b64_tr_b16 v[48:49], v4 offset:16384
    ds_read_b64_tr_b16 v[52:53], v4 offset:16416
    ds_read_b64_tr_b16 v[46:47], v5 offset:19968
    ds_read_b64_tr_b16 v[50:51], v4 offset:19968
    ds_read_b64_tr_b16 v[54:55], v4 offset:20000
    ds_read_b64_tr_b16 v[56:57], v5 offset:24576
    ds_read_b64_tr_b16 v[60:61], v4 offset:24576
    ds_read_b64_tr_b16 v[64:65], v4 offset:24608
    ds_read_b64_tr_b16 v[58:59], v5 offset:28160
    ds_read_b64_tr_b16 v[62:63], v4 offset:28160
    ds_read_b64_tr_b16 v[66:67], v4 offset:28192
    s_waitcnt lgkmcnt(15)
    v_mfma_f32_16x16x32_bf16 v[8:11], v[24:27], v[20:23], 0
    v_mfma_f32_16x16x32_bf16 v[12:15], v[28:31], v[20:23], 0
    s_waitcnt lgkmcnt(12)
    v_mfma_f32_16x16x32_bf16 v[8:11], v[36:39], v[32:35], v[8:11]
    v_mfma_f32_16x16x32_bf16 v[12:15], v[40:43], v[32:35], v[12:15]
    s_waitcnt lgkmcnt(6)
    v_mfma_f32_16x16x32_bf16 v[8:11], v[48:51], v[44:47], v[8:11]
    v_mfma_f32_16x16x32_bf16 v[12:15], v[52:55], v[44:47], v[12:15]
    s_waitcnt lgkmcnt(0)
    v_mfma_f32_16x16x32_bf16 v[8:11], v[60:63], v[56:59], v[8:11]
    v_mfma_f32_16x16x32_bf16 v[12:15], v[64:67], v[56:59], v[12:15]
    s_nop 6
    v_cvt_pk_bf16_f32 v16, v8, v9
    v_cvt_pk_bf16_f32 v17, v10, v11
    v_cvt_pk_bf16_f32 v18, v12, v13
    v_cvt_pk_bf16_f32 v19, v14, v15
    s_nop 0
    v_permlane16_swap_b32 v16, v18
    v_permlane16_swap_b32 v17, v19
    v_and_or_b32 v19, v19, s56, v2
    buffer_store_dwordx4 v[16:19], v6, s[4:7], s54 offen sc1
    v_mov_b32 v36, v204
    v_mov_b32 v46, v205
    s_mov_b32 vcc_lo, 0xf0f00f0f
    s_mov_b32 vcc_hi, 0xf0f00f0f
    v_mov_b32 v48, 0x3f803f80
    v_cndmask_b32 v48, 0, v48, vcc
    v_mov_b32 v49, v48
    v_mov_b32 v50, v48
    v_mov_b32 v51, v48
    s_mul_i32 s3, s50, 384
    v_lshl_add_u32 v45, v0, 2, s3
    s_waitcnt vmcnt(7)
    v_mov_b32 v24, v206
    v_mov_b32 v25, v207
    ds_read_b64_tr_b16 v[176:177], v46 offset:0
    ds_read_b64_tr_b16 v[178:179], v46 offset:256
    ds_read_b64_tr_b16 v[180:181], v46 offset:4096
    ds_read_b64_tr_b16 v[182:183], v46 offset:4352
    ds_read_b64_tr_b16 v[184:185], v46 offset:8192
    ds_read_b64_tr_b16 v[186:187], v46 offset:8448
    ds_read_b64_tr_b16 v[188:189], v46 offset:12288
    ds_read_b64_tr_b16 v[190:191], v46 offset:12544
    ds_read_b64_tr_b16 v[192:193], v46 offset:16384
    ds_read_b64_tr_b16 v[194:195], v46 offset:16640
    ds_read_b64_tr_b16 v[196:197], v46 offset:20480
    ds_read_b64_tr_b16 v[198:199], v46 offset:20736
    ds_read_b64_tr_b16 v[200:201], v46 offset:24576
    ds_read_b64_tr_b16 v[202:203], v46 offset:24832
    v_mul_f32 v37, 0x42e00000, v36
    s_waitcnt lgkmcnt(10)
    v_mfma_f32_16x16x32_bf16 v[56:59], v[48:51], v[176:179], 0
    v_mfma_f32_16x16x32_bf16 v[56:59], v[48:51], v[180:183], v[56:59]
    s_waitcnt lgkmcnt(6)
    v_mfma_f32_16x16x32_bf16 v[56:59], v[48:51], v[184:187], v[56:59]
    v_mfma_f32_16x16x32_bf16 v[56:59], v[48:51], v[188:191], v[56:59]
    s_waitcnt lgkmcnt(2)
    v_mfma_f32_16x16x32_bf16 v[56:59], v[48:51], v[192:195], v[56:59]
    v_mfma_f32_16x16x32_bf16 v[56:59], v[48:51], v[196:199], v[56:59]
    s_waitcnt lgkmcnt(0)
    v_mfma_f32_16x16x32_bf16 v[56:59], v[48:51], v[200:203], v[56:59]
    s_nop 7
    v_cmp_neq_f32 vcc, v56, v37
    s_nop 0
    s_and_b64 vcc, vcc, 0xc0000000
    s_cbranch_vccz L_rg_14
L_rt_13:
    s_add_u32 s44, s26, 0
    s_add_u32 m0, s46, 60672
    s_nop 0
    buffer_load_dwordx4 v3, s[4:7], s44 offen sc1 lds
    s_add_u32 s44, s26, 4096
    s_add_u32 m0, s46, 64768
    s_nop 0
    buffer_load_dwordx4 v3, s[4:7], s44 offen sc1 lds
    s_add_u32 s44, s26, 8192
    s_add_u32 m0, s46, 68864
    s_nop 0
    buffer_load_dwordx4 v3, s[4:7], s44 offen sc1 lds
    s_add_u32 s44, s26, 12288
    s_add_u32 m0, s46, 72960
    s_nop 0
    buffer_load_dwordx4 v3, s[4:7], s44 offen sc1 lds
    s_add_u32 s44, s26, 16384
    s_add_u32 m0, s46, 77056
    s_nop 0
    buffer_load_dwordx4 v3, s[4:7], s44 offen sc1 lds
    s_add_u32 s44, s26, 20480
    s_add_u32 m0, s46, 81152
    s_nop 0
    buffer_load_dwordx4 v3, s[4:7], s44 offen sc1 lds
    s_add_u32 s44, s26, 24576
    s_add_u32 m0, s46, 85248
    s_nop 0
    buffer_load_dwordx4 v3, s[4:7], s44 offen sc1 lds
    s_waitcnt vmcnt(0)
    ds_read_b64_tr_b16 v[176:177], v46 offset:0
    ds_read_b64_tr_b16 v[178:179], v46 offset:256
    ds_read_b64_tr_b16 v[180:181], v46 offset:4096
    ds_read_b64_tr_b16 v[182:183], v46 offset:4352
    ds_read_b64_tr_b16 v[184:185], v46 offset:8192
    ds_read_b64_tr_b16 v[186:187], v46 offset:8448
    ds_read_b64_tr_b16 v[188:189], v46 offset:12288
    ds_read_b64_tr_b16 v[190:191], v46 offset:12544
    ds_read_b64_tr_b16 v[192:193], v46 offset:16384
    ds_read_b64_tr_b16 v[194:195], v46 offset:16640
    ds_read_b64_tr_b16 v[196:197], v46 offset:20480
    ds_read_b64_tr_b16 v[198:199], v46 offset:20736
    ds_read_b64_tr_b16 v[200:201], v46 offset:24576
    ds_read_b64_tr_b16 v[202:203], v46 offset:24832
    v_mul_f32 v37, 0x42e00000, v36
    s_waitcnt lgkmcnt(10)
    v_mfma_f32_16x16x32_bf16 v[56:59], v[48:51], v[176:179], 0
    v_mfma_f32_16x16x32_bf16 v[56:59], v[48:51], v[180:183], v[56:59]
    s_waitcnt lgkmcnt(6)
    v_mfma_f32_16x16x32_bf16 v[56:59], v[48:51], v[184:187], v[56:59]
    v_mfma_f32_16x16x32_bf16 v[56:59], v[48:51], v[188:191], v[56:59]
    s_waitcnt lgkmcnt(2)
    v_mfma_f32_16x16x32_bf16 v[56:59], v[48:51], v[192:195], v[56:59]
    v_mfma_f32_16x16x32_bf16 v[56:59], v[48:51], v[196:199], v[56:59]
    s_waitcnt lgkmcnt(0)
    v_mfma_f32_16x16x32_bf16 v[56:59], v[48:51], v[200:203], v[56:59]
    s_nop 7
    v_cmp_neq_f32 vcc, v56, v37
    s_nop 0
    s_and_b64 vcc, vcc, 0xc0000000
    s_cbranch_vccz L_ok_15
    s_cmp_eq_u32 s53, 0
    s_cbranch_scc1 L_ok_15
    s_sub_u32 s53, s53, 1
    s_branch L_rt_13
L_ok_15:
L_rg_14:
    s_mov_b32 exec_hi, 0
    ds_write_b32 v45, v56 offset:57984
    s_mov_b32 exec_hi, -1
    s_waitcnt lgkmcnt(0)
    s_barrier
    s_cmp_lg_u32 s50, 0
    s_cbranch_scc1 L_nored_16
    v_and_b32 v8, 1, v0
    v_lshlrev_b32 v8, 4, v8
    v_mov_b32 v9, 0x3f80
    v_lshlrev_b32 v8, v8, v9
    s_mov_b32 vcc_lo, 0x30003
    s_mov_b32 vcc_hi, 0x30003
    v_cndmask_b32 v52, 0, v8, vcc
    s_mov_b32 vcc_lo, 0xc000c
    s_mov_b32 vcc_hi, 0xc000c
    v_cndmask_b32 v53, 0, v8, vcc
    s_mov_b32 vcc_lo, 0x300030
    s_mov_b32 vcc_hi, 0x300030
    v_cndmask_b32 v54, 0, v8, vcc
    s_mov_b32 vcc_lo, 0xc000c0
    s_mov_b32 vcc_hi, 0xc000c0
    v_cndmask_b32 v55, 0, v8, vcc
    s_lshl_b32 s71, s49, 4
    s_add_u32 s71, s71, s48
    s_lshl_b32 s55, s71, 8
    s_lshl_b32 s71, s71, 12
    s_add_u32 s71, s71, 2097152
    s_add_u32 s55, s55, 1835008
    v_and_b32 v9, 16, v0
    v_mul_u32_u24 v9, 31, v9
    v_lshrrev_b32 v9, 1, v9
    v_sub_u32 v9, v1, v9
    s_sleep 2
L_kv_17:
    buffer_load_dwordx4 v[36:39], v1, s[4:7], s71 offen offset:0 sc1
    buffer_load_dwordx4 v[40:43], v1, s[4:7], s71 offen offset:1024 sc1
    buffer_load_dwordx4 v[44:47], v1, s[4:7], s71 offen offset:2048 sc1
    buffer_load_dwordx4 v[48:51], v1, s[4:7], s71 offen offset:3072 sc1
    s_waitcnt vmcnt(0)
    v_mfma_f32_16x16x32_bf16 v[12:15], v[52:55], v[36:39], 0
    v_mfma_f32_16x16x32_bf16 v[12:15], v[52:55], v[40:43], v[12:15]
    v_mfma_f32_16x16x32_bf16 v[12:15], v[52:55], v[44:47], v[12:15]
    v_mfma_f32_16x16x32_bf16 v[12:15], v[52:55], v[48:51], v[12:15]
    v_xor_b32 v8, v39, v2
    v_bitop3_b32 v8, v8, v43, v2 bitop3:0xf6
    v_bitop3_b32 v8, v8, v47, v2 bitop3:0xf6
    v_bitop3_b32 v8, v8, v51, v2 bitop3:0xf6
    v_cmp_lt_u32 vcc, 0xffff, v8
    s_nop 0
    s_cbranch_vccz L_ok_18
    s_cmp_eq_u32 s53, 0
    s_cbranch_scc1 L_ok_18
    s_sub_u32 s53, s53, 1
    s_branch L_kv_17
L_ok_18:
    s_mov_b32 vcc_lo, 0xffff0000
    s_mov_b32 exec_hi, 0
    v_cndmask_b32 v15, v15, v2, vcc
    v_cvt_pk_bf16_f32 v10, v12, v13
    v_cvt_pk_bf16_f32 v11, v14, v15
    buffer_store_dwordx2 v[10:11], v9, s[4:7], s55 offen sc1
    s_mov_b32 exec_hi, -1
    v_lshrrev_b32 v30, 4, v0
    v_mul_u32_u24 v30, 96256, v30
    v_lshl_add_u32 v30, v0, 7, v30
    s_add_u32 s3, s22, 0
    buffer_load_dword v31, v30, s[4:7], s3 offen sc1
L_nored_16:
    s_mul_i32 s55, s51, 0x9e3779b1
    v_cmp_ne_u32 vcc, s55, v24
    s_nop 0
    s_cbranch_vccz L_rg_20
L_rt_19:
    s_lshl_b32 s3, s48, 11
    s_add_u32 s3, s3, 4096
    v_and_b32 v26, 15, v0
    v_lshlrev_b32 v26, 7, v26
    buffer_load_dwordx2 v[24:25], v26, s[4:7], s3 offen sc1
    s_waitcnt vmcnt(0)
    v_cmp_ne_u32 vcc, s55, v24
    s_nop 0
    s_cbranch_vccz L_ok_21
    s_cmp_eq_u32 s53, 0
    s_cbranch_scc1 L_ok_21
    s_sub_u32 s53, s53, 1
    s_branch L_rt_19
L_ok_21:
L_rg_20:
    s_getreg_b32 s55, hwreg(HW_REG_XCC_ID, 0, 4)
    v_cmp_ne_u32 vcc, s55, v25
    s_nop 0
    s_mov_b32 s52, vcc_lo
    s_add_u32 s62, s19, 14336
    v_mov_b32 v20, -1
    v_mov_b32 v21, -1
    v_mov_b32 v22, -1
    v_mov_b32 v23, -1
    s_add_u32 s3, s22, 65536
    buffer_store_dwordx4 v[20:23], v1, s[4:7], s3 offen offset:0 sc1
    buffer_store_dwordx4 v[20:23], v1, s[4:7], s3 offen offset:1024 sc1
    s_movk_i32 s56, 3072
    v_min_u32 v8, 11, v0
    v_lshrrev_b32 v9, 2, v8
    v_mul_u32_u24 v9, 28736, v9
    v_lshl_add_u32 v9, v8, 4, v9
    v_lshrrev_b32 v8, 3, v8
    v_mad_u32_u24 v9, v8, s56, v9
    ds_read_b128 v[12:15], v9 offset:14336
    s_waitcnt lgkmcnt(0)
    ds_write_b128 v9, v[12:15] offset:28672
    buffer_load_dwordx4 v[88:91], v1, s[4:7], s47 offen offset:2048 sc1
    buffer_load_dwordx4 v[92:95], v1, s[4:7], s47 offen offset:3072 sc1
    s_lshl_b32 s47, s64, 15
    s_add_u32 s47, s47, 266240
    buffer_load_dwordx4 v[96:99], v1, s[4:7], s47 offen offset:0 sc1
    buffer_load_dwordx4 v[100:103], v1, s[4:7], s47 offen offset:1024 sc1
    buffer_load_dwordx4 v[104:107], v1, s[4:7], s47 offen offset:2048 sc1
    buffer_load_dwordx4 v[108:111], v1, s[4:7], s47 offen offset:3072 sc1
    s_lshl_b32 s47, s64, 15
    s_add_u32 s47, s47, 270336
    buffer_load_dwordx4 v[112:115], v1, s[4:7], s47 offen offset:0 sc1
    buffer_load_dwordx4 v[116:119], v1, s[4:7], s47 offen offset:1024 sc1
    buffer_load_dwordx4 v[120:123], v1, s[4:7], s47 offen offset:2048 sc1
    buffer_load_dwordx4 v[124:127], v1, s[4:7], s47 offen offset:3072 sc1
    s_lshl_b32 s47, s64, 15
    s_add_u32 s47, s47, 274432
    buffer_load_dwordx4 v[128:131], v1, s[4:7], s47 offen offset:0 sc1
    buffer_load_dwordx4 v[132:135], v1, s[4:7], s47 offen offset:1024 sc1
    buffer_load_dwordx4 v[136:139], v1, s[4:7], s47 offen offset:2048 sc1
    buffer_load_dwordx4 v[140:143], v1, s[4:7], s47 offen offset:3072 sc1
    s_lshl_b32 s47, s64, 15
    s_add_u32 s47, s47, 278528
    buffer_load_dwordx4 v[144:147], v1, s[4:7], s47 offen offset:0 sc1
    buffer_load_dwordx4 v[148:151], v1, s[4:7], s47 offen offset:1024 sc1
    buffer_load_dwordx4 v[152:155], v1, s[4:7], s47 offen offset:2048 sc1
    buffer_load_dwordx4 v[156:159], v1, s[4:7], s47 offen offset:3072 sc1
    s_lshl_b32 s47, s64, 15
    s_add_u32 s47, s47, 282624
    buffer_load_dwordx4 v[160:163], v1, s[4:7], s47 offen offset:0 sc1
    buffer_load_dwordx4 v[164:167], v1, s[4:7], s47 offen offset:1024 sc1
    buffer_load_dwordx4 v[168:171], v1, s[4:7], s47 offen offset:2048 sc1
    buffer_load_dwordx4 v[172:175], v1, s[4:7], s47 offen offset:3072 sc1
    s_lshl_b32 s47, s64, 15
    s_add_u32 s47, s47, 286720
    buffer_load_dwordx4 v[176:179], v1, s[4:7], s47 offen offset:0 sc1
    buffer_load_dwordx4 v[180:183], v1, s[4:7], s47 offen offset:1024 sc1
    buffer_load_dwordx4 v[184:187], v1, s[4:7], s47 offen offset:2048 sc1
    buffer_load_dwordx4 v[188:191], v1, s[4:7], s47 offen offset:3072 sc1
    s_lshl_b32 s47, s64, 15
    s_add_u32 s47, s47, 290816
    buffer_load_dwordx4 v[192:195], v1, s[4:7], s47 offen offset:0 sc1
    buffer_load_dwordx4 v[196:199], v1, s[4:7], s47 offen offset:1024 sc1
    buffer_load_dwordx4 v[200:203], v1, s[4:7], s47 offen offset:2048 sc1
    buffer_load_dwordx4 v[204:207], v1, s[4:7], s47 offen offset:3072 sc1
    s_lshl_b32 s56, s49, 12
    s_add_u32 s56, s56, 1835008
    v_add_u32 v9, 89600, v1
    s_cmp_lg_u32 s50, 0
    s_cbranch_scc1 L_nokf_22
    s_sleep 4
L_kf_23:
    buffer_load_dwordx4 v[36:39], v1, s[4:7], s56 offen offset:0 sc1
    buffer_load_dwordx4 v[40:43], v1, s[4:7], s56 offen offset:1024 sc1
    buffer_load_dwordx4 v[44:47], v1, s[4:7], s56 offen offset:2048 sc1
    buffer_load_dwordx4 v[48:51], v1, s[4:7], s56 offen offset:3072 sc1
    s_waitcnt vmcnt(3)
    ds_write_b128 v9, v[36:39] offset:0
    s_waitcnt vmcnt(2)
    ds_write_b128 v9, v[40:43] offset:1024
    s_waitcnt vmcnt(1)
    ds_write_b128 v9, v[44:47] offset:2048
    s_waitcnt vmcnt(0)
    ds_write_b128 v9, v[48:51] offset:3072
    v_xor_b32 v8, v39, v2
    v_bitop3_b32 v8, v8, v43, v2 bitop3:0xf6
    v_bitop3_b32 v8, v8, v47, v2 bitop3:0xf6
    v_bitop3_b32 v8, v8, v51, v2 bitop3:0xf6
    v_cmp_lt_u32 vcc, 0xffff, v8
    s_nop 0
    s_cbranch_vccz L_ok_24
    s_cmp_eq_u32 s53, 0
    s_cbranch_scc1 L_ok_24
    s_sub_u32 s53, s53, 1
    s_branch L_kf_23
L_ok_24:
L_nokf_22:
    s_waitcnt vmcnt(0) lgkmcnt(0)
    s_barrier
L_g2_25:
    s_xor_b32 s54, s64, s61
    s_sub_u32 s55, 27, s64
    s_add_u32 s57, s55, 1
    s_cmp_eq_u32 s64, 0
    s_cselect_b32 s57, 14, s57
    s_xor_b32 s55, s55, s61
    s_xor_b32 s57, s57, s61
    v_add_u32 v8, 126464, v1
    v_lshl_add_u32 v9, s54, 10, v8
    v_lshl_add_u32 v10, s55, 10, v8
    v_lshl_add_u32 v11, s57, 10, v8
    ds_read_b128 v[36:39], v9
    ds_read_b128 v[40:43], v10
    ds_read_b128 v[44:47], v11
    v_and_b32 v8, 7, v0
    v_bfe_u32 v9, v0, 4, 1
    v_lshl_add_u32 v8, v9, 3, v8
    v_sub_u32 v9, 16, v8
    s_mov_b32 vcc_lo, 0xff00ff00
    s_mov_b32 vcc_hi, 0xff00ff00
    v_cndmask_b32 v8, v8, v9, vcc
    v_and_b32 v9, 1, v8
    v_lshlrev_b32 v9, 4, v9
    v_mov_b32 v10, 0x3f80
    v_lshlrev_b32 v9, v9, v10
    v_lshrrev_b32 v8, 1, v8
    v_lshrrev_b32 v11, 5, v0
    v_lshlrev_b32 v11, 2, v11
    v_sub_u32 v8, v8, v11
    v_cmp_eq_u32_e64 s[54:55], 0, v8
    s_nop 1
    v_cndmask_b32_e64 v11, 0, v9, s[54:55]
    v_cndmask_b32_e64 v48, v11, 0, vcc
    v_cndmask_b32 v52, 0, v11, vcc
    v_mov_b32 v56, 0
    v_cmp_eq_u32_e64 s[54:55], 1, v8
    s_nop 1
    v_cndmask_b32_e64 v11, 0, v9, s[54:55]
    v_cndmask_b32_e64 v49, v11, 0, vcc
    v_cndmask_b32 v53, 0, v11, vcc
    v_mov_b32 v57, 0
    v_cmp_eq_u32_e64 s[54:55], 2, v8
    s_nop 1
    v_cndmask_b32_e64 v11, 0, v9, s[54:55]
    v_cndmask_b32_e64 v50, v11, 0, vcc
    v_cndmask_b32 v54, 0, v11, vcc
    v_mov_b32 v58, 0
    v_cmp_eq_u32_e64 s[54:55], 3, v8
    s_nop 1
    v_cndmask_b32_e64 v11, 0, v9, s[54:55]
    v_cndmask_b32_e64 v51, v11, 0, vcc
    v_cndmask_b32 v55, 0, v11, vcc
    v_mov_b32 v59, 0
    s_movk_i32 s3, 0x3f80
    v_writelane_b32 v56, s3, 8
    s_waitcnt lgkmcnt(0)
    v_mfma_f32_32x32x16_bf16 v[20:35], v[48:51], v[36:39], 0
    v_mfma_f32_32x32x16_bf16 v[20:35], v[52:55], v[40:43], v[20:35]
    v_mfma_f32_32x32x16_bf16 v[20:35], v[56:59], v[44:47], v[20:35]
    v_and_b32 v10, 0x87ff0000, v2
    v_or_b32 v10, 0x08000000, v10
    s_waitcnt vmcnt(0)
    v_xor_b32 v8, v83, v10
    v_bitop3_b32 v8, v8, v87, v10 bitop3:0xf6
    v_bitop3_b32 v8, v8, v91, v10 bitop3:0xf6
    v_bitop3_b32 v8, v8, v95, v10 bitop3:0xf6
    v_bitop3_b32 v8, v8, v99, v10 bitop3:0xf6
    v_bitop3_b32 v8, v8, v103, v10 bitop3:0xf6
    v_bitop3_b32 v8, v8, v107, v10 bitop3:0xf6
    v_bitop3_b32 v8, v8, v111, v10 bitop3:0xf6
    v_bitop3_b32 v8, v8, v115, v10 bitop3:0xf6
    v_bitop3_b32 v8, v8, v119, v10 bitop3:0xf6
    v_bitop3_b32 v8, v8, v123, v10 bitop3:0xf6
    v_bitop3_b32 v8, v8, v127, v10 bitop3:0xf6
    v_bitop3_b32 v8, v8, v131, v10 bitop3:0xf6
    v_bitop3_b32 v8, v8, v135, v10 bitop3:0xf6
    v_bitop3_b32 v8, v8, v139, v10 bitop3:0xf6
    v_bitop3_b32 v8, v8, v143, v10 bitop3:0xf6
    v_bitop3_b32 v8, v8, v147, v10 bitop3:0xf6
    v_bitop3_b32 v8, v8, v151, v10 bitop3:0xf6
    v_bitop3_b32 v8, v8, v155, v10 bitop3:0xf6
    v_bitop3_b32 v8, v8, v159, v10 bitop3:0xf6
    v_bitop3_b32 v8, v8, v163, v10 bitop3:0xf6
    v_bitop3_b32 v8, v8, v167, v10 bitop3:0xf6
    v_bitop3_b32 v8, v8, v171, v10 bitop3:0xf6
    v_bitop3_b32 v8, v8, v175, v10 bitop3:0xf6
    v_bitop3_b32 v8, v8, v179, v10 bitop3:0xf6
    v_bitop3_b32 v8, v8, v183, v10 bitop3:0xf6
    v_bitop3_b32 v8, v8, v187, v10 bitop3:0xf6
    v_bitop3_b32 v8, v8, v191, v10 bitop3:0xf6
    v_bitop3_b32 v8, v8, v195, v10 bitop3:0xf6
    v_bitop3_b32 v8, v8, v199, v10 bitop3:0xf6
    v_bitop3_b32 v8, v8, v203, v10 bitop3:0xf6
    v_bitop3_b32 v8, v8, v207, v10 bitop3:0xf6
    v_cmp_lt_u32 vcc, 0xffff, v8
    s_nop 0
    s_cbranch_vccz L_rg_27
L_rt_26:
    s_lshl_b32 s47, s64, 15
    s_add_u32 s47, s47, 262144
    buffer_load_dwordx4 v[80:83], v1, s[4:7], s47 offen offset:0 sc1
    buffer_load_dwordx4 v[84:87], v1, s[4:7], s47 offen offset:1024 sc1
    buffer_load_dwordx4 v[88:91], v1, s[4:7], s47 offen offset:2048 sc1
    buffer_load_dwordx4 v[92:95], v1, s[4:7], s47 offen offset:3072 sc1
    s_lshl_b32 s47, s64, 15
    s_add_u32 s47, s47, 266240
    buffer_load_dwordx4 v[96:99], v1, s[4:7], s47 offen offset:0 sc1
    buffer_load_dwordx4 v[100:103], v1, s[4:7], s47 offen offset:1024 sc1
    buffer_load_dwordx4 v[104:107], v1, s[4:7], s47 offen offset:2048 sc1
    buffer_load_dwordx4 v[108:111], v1, s[4:7], s47 offen offset:3072 sc1
    s_lshl_b32 s47, s64, 15
    s_add_u32 s47, s47, 270336
    buffer_load_dwordx4 v[112:115], v1, s[4:7], s47 offen offset:0 sc1
    buffer_load_dwordx4 v[116:119], v1, s[4:7], s47 offen offset:1024 sc1
    buffer_load_dwordx4 v[120:123], v1, s[4:7], s47 offen offset:2048 sc1
    buffer_load_dwordx4 v[124:127], v1, s[4:7], s47 offen offset:3072 sc1
    s_lshl_b32 s47, s64, 15
    s_add_u32 s47, s47, 274432
    buffer_load_dwordx4 v[128:131], v1, s[4:7], s47 offen offset:0 sc1
    buffer_load_dwordx4 v[132:135], v1, s[4:7], s47 offen offset:1024 sc1
    buffer_load_dwordx4 v[136:139], v1, s[4:7], s47 offen offset:2048 sc1
    buffer_load_dwordx4 v[140:143], v1, s[4:7], s47 offen offset:3072 sc1
    s_lshl_b32 s47, s64, 15
    s_add_u32 s47, s47, 278528
    buffer_load_dwordx4 v[144:147], v1, s[4:7], s47 offen offset:0 sc1
    buffer_load_dwordx4 v[148:151], v1, s[4:7], s47 offen offset:1024 sc1
    buffer_load_dwordx4 v[152:155], v1, s[4:7], s47 offen offset:2048 sc1
    buffer_load_dwordx4 v[156:159], v1, s[4:7], s47 offen offset:3072 sc1
    s_lshl_b32 s47, s64, 15
    s_add_u32 s47, s47, 282624
    buffer_load_dwordx4 v[160:163], v1, s[4:7], s47 offen offset:0 sc1
    buffer_load_dwordx4 v[164:167], v1, s[4:7], s47 offen offset:1024 sc1
    buffer_load_dwordx4 v[168:171], v1, s[4:7], s47 offen offset:2048 sc1
    buffer_load_dwordx4 v[172:175], v1, s[4:7], s47 offen offset:3072 sc1
    s_lshl_b32 s47, s64, 15
    s_add_u32 s47, s47, 286720
    buffer_load_dwordx4 v[176:179], v1, s[4:7], s47 offen offset:0 sc1
    buffer_load_dwordx4 v[180:183], v1, s[4:7], s47 offen offset:1024 sc1
    buffer_load_dwordx4 v[184:187], v1, s[4:7], s47 offen offset:2048 sc1
    buffer_load_dwordx4 v[188:191], v1, s[4:7], s47 offen offset:3072 sc1
    s_lshl_b32 s47, s64, 15
    s_add_u32 s47, s47, 290816
    buffer_load_dwordx4 v[192:195], v1, s[4:7], s47 offen offset:0 sc1
    buffer_load_dwordx4 v[196:199], v1, s[4:7], s47 offen offset:1024 sc1
    buffer_load_dwordx4 v[200:203], v1, s[4:7], s47 offen offset:2048 sc1
    buffer_load_dwordx4 v[204:207], v1, s[4:7], s47 offen offset:3072 sc1
    s_waitcnt vmcnt(0)
    v_xor_b32 v8, v83, v10
    v_bitop3_b32 v8, v8, v87, v10 bitop3:0xf6
    v_bitop3_b32 v8, v8, v91, v10 bitop3:0xf6
    v_bitop3_b32 v8, v8, v95, v10 bitop3:0xf6
    v_bitop3_b32 v8, v8, v99, v10 bitop3:0xf6
    v_bitop3_b32 v8, v8, v103, v10 bitop3:0xf6
    v_bitop3_b32 v8, v8, v107, v10 bitop3:0xf6
    v_bitop3_b32 v8, v8, v111, v10 bitop3:0xf6
    v_bitop3_b32 v8, v8, v115, v10 bitop3:0xf6
    v_bitop3_b32 v8, v8, v119, v10 bitop3:0xf6
    v_bitop3_b32 v8, v8, v123, v10 bitop3:0xf6
    v_bitop3_b32 v8, v8, v127, v10 bitop3:0xf6
    v_bitop3_b32 v8, v8, v131, v10 bitop3:0xf6
    v_bitop3_b32 v8, v8, v135, v10 bitop3:0xf6
    v_bitop3_b32 v8, v8, v139, v10 bitop3:0xf6
    v_bitop3_b32 v8, v8, v143, v10 bitop3:0xf6
    v_bitop3_b32 v8, v8, v147, v10 bitop3:0xf6
    v_bitop3_b32 v8, v8, v151, v10 bitop3:0xf6
    v_bitop3_b32 v8, v8, v155, v10 bitop3:0xf6
    v_bitop3_b32 v8, v8, v159, v10 bitop3:0xf6
    v_bitop3_b32 v8, v8, v163, v10 bitop3:0xf6
    v_bitop3_b32 v8, v8, v167, v10 bitop3:0xf6
    v_bitop3_b32 v8, v8, v171, v10 bitop3:0xf6
    v_bitop3_b32 v8, v8, v175, v10 bitop3:0xf6
    v_bitop3_b32 v8, v8, v179, v10 bitop3:0xf6
    v_bitop3_b32 v8, v8, v183, v10 bitop3:0xf6
    v_bitop3_b32 v8, v8, v187, v10 bitop3:0xf6
    v_bitop3_b32 v8, v8, v191, v10 bitop3:0xf6
    v_bitop3_b32 v8, v8, v195, v10 bitop3:0xf6
    v_bitop3_b32 v8, v8, v199, v10 bitop3:0xf6
    v_bitop3_b32 v8, v8, v203, v10 bitop3:0xf6
    v_bitop3_b32 v8, v8, v207, v10 bitop3:0xf6
    v_cmp_lt_u32 vcc, 0xffff, v8
    s_nop 0
    s_cbranch_vccz L_ok_28
    s_cmp_eq_u32 s53, 0
    s_cbranch_scc1 L_ok_28
    s_sub_u32 s53, s53, 1
    s_branch L_rt_26
L_ok_28:
L_rg_27:
    v_add_u32 v8, 93696, v1
    v_add_u32 v9, 126464, v1
    s_bitcmp1_b32 s49, 0
    s_cselect_b32 s3, 0, 14336
    v_add_u32 v10, s3, v9
    s_cmp_eq_u32 s65, 0
    s_cselect_b32 s57, 268435456, s19
    s_cselect_b32 s62, 268435456, s62
    s_cselect_b32 s71, 268435456, s25
    s_add_u32 s54, s24, 4194304
    s_add_u32 s55, s24, 5111808
    s_cmp_eq_u32 s59, 0
    s_cselect_b32 s54, 268435456, s54
    s_cselect_b32 s55, 268435456, s55
    v_mov_b32 v11, 0
    v_mov_b32 v12, 60160
    s_barrier
    ds_write_b32 v12, v11
    ds_read_b128 v[36:39], v8 offset:0
    ds_read_b128 v[40:43], v8 offset:8192
    ds_read_b128 v[44:47], v8 offset:16384
    ds_read_b128 v[48:51], v8 offset:24576
    ds_read_b128 v[52:55], v8 offset:1024
    ds_read_b128 v[56:59], v8 offset:9216
    s_waitcnt lgkmcnt(5)
    v_mfma_f32_32x32x16_bf16 v[20:35], v[80:83], v[36:39], v[20:35]
    v_bitop3_b32 v11, v11, v39, v2 bitop3:0xf6
    ds_read_b128 v[60:63], v8 offset:17408
    s_waitcnt lgkmcnt(5)
    v_mfma_f32_32x32x16_bf16 v[20:35], v[112:115], v[40:43], v[20:35]
    v_bitop3_b32 v11, v11, v43, v2 bitop3:0xf6
    ds_read_b128 v[64:67], v8 offset:25600
    s_waitcnt lgkmcnt(5)
    v_mfma_f32_32x32x16_bf16 v[20:35], v[144:147], v[44:47], v[20:35]
    v_bitop3_b32 v11, v11, v47, v2 bitop3:0xf6
    s_barrier
    ds_read_b128 v[36:39], v8 offset:2048
    s_waitcnt lgkmcnt(5)
    v_mfma_f32_32x32x16_bf16 v[20:35], v[176:179], v[48:51], v[20:35]
    v_bitop3_b32 v11, v11, v51, v2 bitop3:0xf6
    ds_read_b128 v[40:43], v8 offset:10240
    s_waitcnt lgkmcnt(5)
    v_mfma_f32_32x32x16_bf16 v[20:35], v[84:87], v[52:55], v[20:35]
    v_bitop3_b32 v11, v11, v55, v2 bitop3:0xf6
    ds_read_b128 v[44:47], v8 offset:18432
    s_waitcnt lgkmcnt(5)
    v_mfma_f32_32x32x16_bf16 v[20:35], v[116:119], v[56:59], v[20:35]
    v_bitop3_b32 v11, v11, v59, v2 bitop3:0xf6
    ds_read_b128 v[48:51], v8 offset:26624
    s_waitcnt lgkmcnt(5)
    v_mfma_f32_32x32x16_bf16 v[20:35], v[148:151], v[60:63], v[20:35]
    v_bitop3_b32 v11, v11, v63, v2 bitop3:0xf6
    ds_read_b128 v[52:55], v8 offset:3072
    s_waitcnt lgkmcnt(5)
    v_mfma_f32_32x32x16_bf16 v[20:35], v[180:183], v[64:67], v[20:35]
    v_bitop3_b32 v11, v11, v67, v2 bitop3:0xf6
    ds_read_b128 v[56:59], v8 offset:11264
    s_waitcnt lgkmcnt(5)
    v_mfma_f32_32x32x16_bf16 v[20:35], v[88:91], v[36:39], v[20:35]
    v_bitop3_b32 v11, v11, v39, v2 bitop3:0xf6
    ds_read_b128 v[60:63], v8 offset:19456
    s_waitcnt lgkmcnt(5)
    v_mfma_f32_32x32x16_bf16 v[20:35], v[120:123], v[40:43], v[20:35]
    v_bitop3_b32 v11, v11, v43, v2 bitop3:0xf6
    ds_read_b128 v[64:67], v8 offset:27648
    s_waitcnt lgkmcnt(5)
    v_mfma_f32_32x32x16_bf16 v[20:35], v[152:155], v[44:47], v[20:35]
    v_bitop3_b32 v11, v11, v47, v2 bitop3:0xf6
    s_barrier
    ds_read_b128 v[36:39], v8 offset:4096
    s_waitcnt lgkmcnt(5)
    v_mfma_f32_32x32x16_bf16 v[20:35], v[184:187], v[48:51], v[20:35]
    v_bitop3_b32 v11, v11, v51, v2 bitop3:0xf6
    ds_read_b128 v[40:43], v8 offset:12288
    s_waitcnt lgkmcnt(5)
    v_mfma_f32_32x32x16_bf16 v[20:35], v[92:95], v[52:55], v[20:35]
    v_bitop3_b32 v11, v11, v55, v2 bitop3:0xf6
    ds_read_b128 v[44:47], v8 offset:20480
    s_waitcnt lgkmcnt(5)
    v_mfma_f32_32x32x16_bf16 v[20:35], v[124:127], v[56:59], v[20:35]
    v_bitop3_b32 v11, v11, v59, v2 bitop3:0xf6
    ds_read_b128 v[48:51], v8 offset:28672
    s_waitcnt lgkmcnt(5)
    v_mfma_f32_32x32x16_bf16 v[20:35], v[156:159], v[60:63], v[20:35]
    v_bitop3_b32 v11, v11, v63, v2 bitop3:0xf6
    ds_read_b128 v[52:55], v8 offset:5120
    s_waitcnt lgkmcnt(5)
    v_mfma_f32_32x32x16_bf16 v[20:35], v[188:191], v[64:67], v[20:35]
    v_bitop3_b32 v11, v11, v67, v2 bitop3:0xf6
    ds_read_b128 v[56:59], v8 offset:13312
    s_waitcnt lgkmcnt(5)
    v_mfma_f32_32x32x16_bf16 v[20:35], v[96:99], v[36:39], v[20:35]
    v_bitop3_b32 v11, v11, v39, v2 bitop3:0xf6
    ds_read_b128 v[60:63], v8 offset:21504
    s_waitcnt lgkmcnt(5)
    v_mfma_f32_32x32x16_bf16 v[20:35], v[128:131], v[40:43], v[20:35]
    v_bitop3_b32 v11, v11, v43, v2 bitop3:0xf6
    ds_read_b128 v[64:67], v8 offset:29696
    s_waitcnt lgkmcnt(5)
    v_mfma_f32_32x32x16_bf16 v[20:35], v[160:163], v[44:47], v[20:35]
    v_bitop3_b32 v11, v11, v47, v2 bitop3:0xf6
    s_barrier
    ds_read_b128 v[36:39], v8 offset:6144
    s_waitcnt lgkmcnt(5)
    v_mfma_f32_32x32x16_bf16 v[20:35], v[192:195], v[48:51], v[20:35]
    v_bitop3_b32 v11, v11, v51, v2 bitop3:0xf6
    ds_read_b128 v[40:43], v8 offset:14336
    s_waitcnt lgkmcnt(5)
    v_mfma_f32_32x32x16_bf16 v[20:35], v[100:103], v[52:55], v[20:35]
    v_bitop3_b32 v11, v11, v55, v2 bitop3:0xf6
    ds_read_b128 v[44:47], v8 offset:22528
    s_waitcnt lgkmcnt(5)
    v_mfma_f32_32x32x16_bf16 v[20:35], v[132:135], v[56:59], v[20:35]
    v_bitop3_b32 v11, v11, v59, v2 bitop3:0xf6
    ds_read_b128 v[48:51], v8 offset:30720
    s_waitcnt lgkmcnt(5)
    v_mfma_f32_32x32x16_bf16 v[20:35], v[164:167], v[60:63], v[20:35]
    v_bitop3_b32 v11, v11, v63, v2 bitop3:0xf6
    ds_read_b128 v[52:55], v8 offset:7168
    s_waitcnt lgkmcnt(5)
    v_mfma_f32_32x32x16_bf16 v[20:35], v[196:199], v[64:67], v[20:35]
    v_bitop3_b32 v11, v11, v67, v2 bitop3:0xf6
    ds_read_b128 v[56:59], v8 offset:15360
    s_waitcnt lgkmcnt(5)
    v_mfma_f32_32x32x16_bf16 v[20:35], v[104:107], v[36:39], v[20:35]
    v_bitop3_b32 v11, v11, v39, v2 bitop3:0xf6
    ds_read_b128 v[60:63], v8 offset:23552
    s_waitcnt lgkmcnt(5)
    v_mfma_f32_32x32x16_bf16 v[20:35], v[136:139], v[40:43], v[20:35]
    v_bitop3_b32 v11, v11, v43, v2 bitop3:0xf6
    ds_read_b128 v[64:67], v8 offset:31744
    s_waitcnt lgkmcnt(5)
    v_mfma_f32_32x32x16_bf16 v[20:35], v[168:171], v[44:47], v[20:35]
    v_bitop3_b32 v11, v11, v47, v2 bitop3:0xf6
    s_waitcnt lgkmcnt(4)
    v_mfma_f32_32x32x16_bf16 v[20:35], v[200:203], v[48:51], v[20:35]
    v_bitop3_b32 v11, v11, v51, v2 bitop3:0xf6
    s_waitcnt lgkmcnt(3)
    v_mfma_f32_32x32x16_bf16 v[20:35], v[108:111], v[52:55], v[20:35]
    v_bitop3_b32 v11, v11, v55, v2 bitop3:0xf6
    s_waitcnt lgkmcnt(2)
    v_mfma_f32_32x32x16_bf16 v[20:35], v[140:143], v[56:59], v[20:35]
    v_bitop3_b32 v11, v11, v59, v2 bitop3:0xf6
    s_waitcnt lgkmcnt(1)
    v_mfma_f32_32x32x16_bf16 v[20:35], v[172:175], v[60:63], v[20:35]
    v_bitop3_b32 v11, v11, v63, v2 bitop3:0xf6
    s_waitcnt lgkmcnt(0)
    v_mfma_f32_32x32x16_bf16 v[20:35], v[204:207], v[64:67], v[20:35]
    v_bitop3_b32 v11, v11, v67, v2 bitop3:0xf6
    v_cmp_lt_u32 vcc, 0xffff, v11
    s_nop 0
    s_cbranch_vccz L_ok_29
    s_cmp_eq_u32 s53, 0
    s_cbranch_scc1 L_ok_29
    s_sub_u32 s53, s53, 1
    v_mov_b32 v12, 60160
    ds_write_b32 v12, v12
    s_waitcnt lgkmcnt(0)
    s_barrier
    s_branch L_g2_25
L_ok_29:
    s_nop 7
    v_pk_add_f32 v[36:37], v[20:21], v[24:25]
    v_pk_add_f32 v[38:39], v[22:23], v[26:27]
    v_pk_add_f32 v[40:41], v[28:29], v[32:33]
    v_pk_add_f32 v[42:43], v[30:31], v[34:35]
    v_pk_add_f32 v[44:45], v[20:21], v[24:25] neg_lo:[0,1] neg_hi:[0,1]
    v_pk_add_f32 v[46:47], v[22:23], v[26:27] neg_lo:[0,1] neg_hi:[0,1]
    v_pk_add_f32 v[48:49], v[28:29], v[32:33] neg_lo:[0,1] neg_hi:[0,1]
    v_pk_add_f32 v[50:51], v[30:31], v[34:35] neg_lo:[0,1] neg_hi:[0,1]
    v_cvt_pk_bf16_f32 v52, v36, v37
    v_cvt_pk_bf16_f32 v53, v38, v39
    v_cvt_pk_bf16_f32 v54, v40, v41
    v_cvt_pk_bf16_f32 v55, v42, v43
    v_cvt_pk_bf16_f32 v56, v44, v45
    v_cvt_pk_bf16_f32 v57, v46, v47
    v_cvt_pk_bf16_f32 v58, v48, v49
    v_cvt_pk_bf16_f32 v59, v50, v51
    s_cmp_eq_u32 s52, 0
    s_cbranch_scc0 L_slow_30
    buffer_store_dwordx4 v[52:55], v1, s[4:7], s57 offen
    buffer_store_dwordx4 v[56:59], v1, s[4:7], s62 offen
    s_branch L_done_31
L_slow_30:
    buffer_store_dwordx4 v[52:55], v1, s[4:7], s57 offen sc1
    buffer_store_dwordx4 v[56:59], v1, s[4:7], s62 offen sc1
L_done_31:
    s_barrier
    v_pk_add_f32 v[14:15], v[36:37], v[38:39]
    v_pk_mul_f32 v[16:17], v[20:21], v[20:21]
    v_pk_fma_f32 v[16:17], v[22:23], v[22:23], v[16:17]
    v_pk_add_f32 v[14:15], v[14:15], v[40:41]
    v_pk_fma_f32 v[16:17], v[24:25], v[24:25], v[16:17]
    v_pk_add_f32 v[14:15], v[14:15], v[42:43]
    v_pk_fma_f32 v[16:17], v[26:27], v[26:27], v[16:17]
    v_pk_fma_f32 v[16:17], v[28:29], v[28:29], v[16:17]
    v_pk_fma_f32 v[16:17], v[30:31], v[30:31], v[16:17]
    v_pk_fma_f32 v[16:17], v[32:33], v[32:33], v[16:17]
    v_pk_fma_f32 v[16:17], v[34:35], v[34:35], v[16:17]
    v_add_f32 v14, v14, v15
    v_add_f32 v16, v16, v17
    s_nop 1
    v_permlane32_swap_b32 v14, v16
    v_add_f32 v14, v14, v16
    s_cmp_eq_u32 s52, 0
    s_cbranch_scc0 L_slow_32
    buffer_store_dword v14, v1, s[4:7], s71 offen
    s_branch L_done_33
L_slow_32:
    buffer_store_dword v14, v1, s[4:7], s71 offen sc1
L_done_33:
    s_and_b32 s56, s36, -16384
    s_and_b32 s3, s49, 1
    s_lshl_b32 s3, s3, 6
    s_add_u32 s56, s56, s3
    s_add_u32 s56, s56, 4194304
    s_add_u32 s57, s56, 8192
    v_add_u32 v11, 151040, v1
    s_barrier
    ds_read_b128 v[36:39], v9 offset:0
    ds_read_b128 v[40:43], v9 offset:5120
    ds_read_b128 v[44:47], v9 offset:10240
    ds_read_b128 v[48:51], v9 offset:1024
    ds_read_b128 v[52:55], v9 offset:6144
    ds_read_b128 v[56:59], v9 offset:11264
    s_waitcnt lgkmcnt(5)
    v_mfma_f32_32x32x16_bf16 v[20:35], v[36:39], a[0:3], 0
    ds_read_b128 v[60:63], v9 offset:2048
    s_waitcnt lgkmcnt(5)
    v_mfma_f32_32x32x16_bf16 v[20:35], v[40:43], a[20:23], v[20:35]
    ds_read_b128 v[64:67], v9 offset:7168
    s_waitcnt lgkmcnt(5)
    v_mfma_f32_32x32x16_bf16 v[20:35], v[44:47], a[40:43], v[20:35]
    ds_read_b128 v[36:39], v9 offset:12288
    s_waitcnt lgkmcnt(5)
    v_mfma_f32_32x32x16_bf16 v[20:35], v[48:51], a[4:7], v[20:35]
    ds_read_b128 v[40:43], v9 offset:3072
    s_waitcnt lgkmcnt(5)
    v_mfma_f32_32x32x16_bf16 v[20:35], v[52:55], a[24:27], v[20:35]
    ds_read_b128 v[44:47], v9 offset:8192
    s_waitcnt lgkmcnt(5)
    v_mfma_f32_32x32x16_bf16 v[20:35], v[56:59], a[44:47], v[20:35]
    ds_read_b128 v[48:51], v9 offset:13312
    s_waitcnt lgkmcnt(5)
    v_mfma_f32_32x32x16_bf16 v[20:35], v[60:63], a[8:11], v[20:35]
    ds_read_b128 v[52:55], v9 offset:4096
    s_waitcnt lgkmcnt(5)
    v_mfma_f32_32x32x16_bf16 v[20:35], v[64:67], a[28:31], v[20:35]
    ds_read_b128 v[56:59], v9 offset:9216
    s_waitcnt lgkmcnt(5)
    v_mfma_f32_32x32x16_bf16 v[20:35], v[36:39], v[68:71], v[20:35]
    ds_read_b128 v[60:63], v10
    s_waitcnt lgkmcnt(5)
    v_mfma_f32_32x32x16_bf16 v[20:35], v[40:43], a[12:15], v[20:35]
    s_waitcnt lgkmcnt(4)
    v_mfma_f32_32x32x16_bf16 v[20:35], v[44:47], a[32:35], v[20:35]
    s_waitcnt lgkmcnt(3)
    v_mfma_f32_32x32x16_bf16 v[20:35], v[48:51], v[72:75], v[20:35]
    s_waitcnt lgkmcnt(2)
    v_mfma_f32_32x32x16_bf16 v[20:35], v[52:55], a[16:19], v[20:35]
    s_waitcnt lgkmcnt(1)
    v_mfma_f32_32x32x16_bf16 v[20:35], v[56:59], a[36:39], v[20:35]
    s_waitcnt lgkmcnt(0)
    v_mfma_f32_32x32x16_bf16 v[20:35], v[60:63], v[76:79], v[20:35]
    s_barrier
    ds_read_b128 v[12:15], v11
    ds_read_b128 v[16:19], v11 offset:1024
    s_nop 8
    v_cvt_pk_bf16_f32 v36, v20, v21
    v_cvt_pk_bf16_f32 v37, v22, v23
    v_cvt_pk_bf16_f32 v38, v24, v25
    v_cvt_pk_bf16_f32 v39, v26, v27
    v_cvt_pk_bf16_f32 v40, v28, v29
    v_cvt_pk_bf16_f32 v41, v30, v31
    v_cvt_pk_bf16_f32 v42, v32, v33
    v_cvt_pk_bf16_f32 v43, v34, v35
    s_waitcnt lgkmcnt(0)
    v_mfma_f32_32x32x16_bf16 v[44:59], v[36:39], v[12:15], 0
    v_mfma_f32_32x32x16_bf16 v[44:59], v[40:43], v[16:19], v[44:59]
    v_and_b32 v8, -64, v3
    v_add_u32 v8, v8, v3
    v_lshrrev_b32 v9, 5, v3
    v_lshlrev_b32 v9, 4, v9
    v_and_b32 v10, 1, v0
    v_lshl_add_u32 v9, v10, 12, v9
    v_add_u32 v9, 142848, v9
    s_nop 4
    v_cvt_pk_bf16_f32 v20, v44, v45
    v_cvt_pk_bf16_f32 v24, v52, v53
    v_cvt_pk_bf16_f32 v21, v46, v47
    v_cvt_pk_bf16_f32 v25, v54, v55
    v_cvt_pk_bf16_f32 v22, v48, v49
    v_cvt_pk_bf16_f32 v26, v56, v57
    v_cvt_pk_bf16_f32 v23, v50, v51
    v_cvt_pk_bf16_f32 v27, v58, v59
    v_permlane16_swap_b32 v20, v24
    v_permlane16_swap_b32 v21, v25
    v_permlane16_swap_b32 v22, v26
    v_permlane16_swap_b32 v23, v27
    buffer_store_dwordx4 v[20:23], v7, s[4:7], s54 offen sc1
    buffer_store_dwordx4 v[24:27], v7, s[4:7], s55 offen sc1
    s_barrier
    s_cmp_ge_u32 s49, 14
    s_cbranch_scc1 L_noc_34
    s_sleep 16
L_c_35:
    buffer_load_dwordx4 v[36:39], v8, s[4:7], s56 offen sc1
    buffer_load_dwordx4 v[40:43], v8, s[4:7], s57 offen sc1
    s_waitcnt vmcnt(1)
    ds_write_b128 v9, v[36:39]
    s_waitcnt vmcnt(0)
    ds_write_b128 v9, v[40:43] offset:2048
    v_max_u32 v10, v36, v40
    v_cmp_eq_u32 vcc, -1, v10
    s_nop 0
    s_cbranch_vccz L_ok_36
    s_cmp_eq_u32 s53, 0
    s_cbranch_scc1 L_ok_36
    s_sub_u32 s53, s53, 1
    s_branch L_c_35
L_ok_36:
    s_waitcnt lgkmcnt(0)
    s_barrier
L_noc_34:
    v_mov_b32 v36, -1
    v_mov_b32 v37, -1
    v_mov_b32 v38, -1
    v_mov_b32 v39, -1
    s_add_u32 s44, s36, 6291456
    buffer_store_dwordx4 v[36:39], v3, s[4:7], s44 offen sc1
    s_add_u32 s44, s36, 6295552
    buffer_store_dwordx4 v[36:39], v3, s[4:7], s44 offen sc1
    s_add_u32 s44, s28, 3145728
    buffer_store_dwordx4 v[36:39], v6, s[4:7], s44 offen sc1
    s_lshl_b32 s44, s49, 4
    s_add_u32 s44, s44, s48
    s_lshl_b32 s44, s44, 8
    s_lshl_b32 s3, s50, 28
    s_add_u32 s44, s44, s3
    s_add_u32 s44, s44, 1900544
    s_mov_b64 exec, 0xffff
    buffer_store_dwordx4 v[36:39], v1, s[4:7], s44 offen sc1
    s_mov_b64 exec, -1
    s_add_u32 s51, s51, 1
    v_and_b32 v8, 15, v0
    v_mul_u32_u24 v8, 0x2f35, v8
    v_add_u32 v8, s51, v8
    v_and_b32 v9, 0x1fff, v8
    v_and_b32 v8, 0x2000, v8
    v_lshl_or_b32 v8, v8, 2, v9
    v_or_b32 v8, 0x2000, v8
    v_lshlrev_b32 v2, 16, v8
    s_nop 0
    v_readlane_b32 s70, v2, 15
    s_waitcnt vmcnt(0)
    s_setprio 1
    s_mov_b32 s56, 0xffff
    s_add_u32 s54, s28, 3145728
    s_barrier
    ds_read_b64_tr_b16 v[20:21], v5 offset:0
    ds_read_b64_tr_b16 v[24:25], v4 offset:0
    ds_read_b64_tr_b16 v[28:29], v4 offset:32
    ds_read_b64_tr_b16 v[22:23], v5 offset:3584
    ds_read_b64_tr_b16 v[26:27], v4 offset:3584
    ds_read_b64_tr_b16 v[30:31], v4 offset:3616
    ds_read_b64_tr_b16 v[32:33], v5 offset:8192
    ds_read_b64_tr_b16 v[36:37], v4 offset:8192
    ds_read_b64_tr_b16 v[40:41], v4 offset:8224
    ds_read_b64_tr_b16 v[34:35], v5 offset:11776
    ds_read_b64_tr_b16 v[38:39], v4 offset:11776
    ds_read_b64_tr_b16 v[42:43], v4 offset:11808
    ds_read_b64_tr_b16 v[44:45], v5 offset:16384
    ds_read_b64_tr_b16 v[48:49], v4 offset:16384
    ds_read_b64_tr_b16 v[52:53], v4 offset:16416
    ds_read_b64_tr_b16 v[46:47], v5 offset:19968
    ds_read_b64_tr_b16 v[50:51], v4 offset:19968
    ds_read_b64_tr_b16 v[54:55], v4 offset:20000
    ds_read_b64_tr_b16 v[56:57], v5 offset:24576
    ds_read_b64_tr_b16 v[60:61], v4 offset:24576
    ds_read_b64_tr_b16 v[64:65], v4 offset:24608
    ds_read_b64_tr_b16 v[58:59], v5 offset:28160
    ds_read_b64_tr_b16 v[62:63], v4 offset:28160
    ds_read_b64_tr_b16 v[66:67], v4 offset:28192
    s_waitcnt lgkmcnt(15)
    v_mfma_f32_16x16x32_bf16 v[8:11], v[24:27], v[20:23], 0
    v_mfma_f32_16x16x32_bf16 v[12:15], v[28:31], v[20:23], 0
    s_waitcnt lgkmcnt(12)
    v_mfma_f32_16x16x32_bf16 v[8:11], v[36:39], v[32:35], v[8:11]
    v_mfma_f32_16x16x32_bf16 v[12:15], v[40:43], v[32:35], v[12:15]
    s_waitcnt lgkmcnt(6)
    v_mfma_f32_16x16x32_bf16 v[8:11], v[48:51], v[44:47], v[8:11]
    v_mfma_f32_16x16x32_bf16 v[12:15], v[52:55], v[44:47], v[12:15]
    s_waitcnt lgkmcnt(0)
    v_mfma_f32_16x16x32_bf16 v[8:11], v[60:63], v[56:59], v[8:11]
    v_mfma_f32_16x16x32_bf16 v[12:15], v[64:67], v[56:59], v[12:15]
    s_nop 6
    v_cvt_pk_bf16_f32 v16, v8, v9
    v_cvt_pk_bf16_f32 v17, v10, v11
    v_cvt_pk_bf16_f32 v18, v12, v13
    v_cvt_pk_bf16_f32 v19, v14, v15
    s_nop 0
    v_permlane16_swap_b32 v16, v18
    v_permlane16_swap_b32 v17, v19
    v_and_or_b32 v19, v19, s56, v2
    buffer_store_dwordx4 v[16:19], v6, s[4:7], s54 offen sc1
    s_barrier
    s_cmp_lg_u32 s50, 0
    s_cbranch_scc1 L_nored_37
    v_and_b32 v8, 1, v0
    v_lshlrev_b32 v8, 4, v8
    v_mov_b32 v9, 0x3f80
    v_lshlrev_b32 v8, v8, v9
    s_mov_b32 vcc_lo, 0x30003
    s_mov_b32 vcc_hi, 0x30003
    v_cndmask_b32 v52, 0, v8, vcc
    s_mov_b32 vcc_lo, 0xc000c
    s_mov_b32 vcc_hi, 0xc000c
    v_cndmask_b32 v53, 0, v8, vcc
    s_mov_b32 vcc_lo, 0x300030
    s_mov_b32 vcc_hi, 0x300030
    v_cndmask_b32 v54, 0, v8, vcc
    s_mov_b32 vcc_lo, 0xc000c0
    s_mov_b32 vcc_hi, 0xc000c0
    v_cndmask_b32 v55, 0, v8, vcc
    s_lshl_b32 s71, s49, 4
    s_add_u32 s71, s71, s48
    s_lshl_b32 s55, s71, 8
    s_lshl_b32 s71, s71, 12
    s_add_u32 s71, s71, 3145728
    s_add_u32 s55, s55, 1900544
    v_and_b32 v9, 16, v0
    v_mul_u32_u24 v9, 31, v9
    v_lshrrev_b32 v9, 1, v9
    v_sub_u32 v9, v1, v9
    s_sleep 10
L_kv_38:
    buffer_load_dwordx4 v[36:39], v1, s[4:7], s71 offen offset:0 sc1
    buffer_load_dwordx4 v[40:43], v1, s[4:7], s71 offen offset:1024 sc1
    buffer_load_dwordx4 v[44:47], v1, s[4:7], s71 offen offset:2048 sc1
    buffer_load_dwordx4 v[48:51], v1, s[4:7], s71 offen offset:3072 sc1
    s_waitcnt vmcnt(0)
    v_mfma_f32_16x16x32_bf16 v[12:15], v[52:55], v[36:39], 0
    v_mfma_f32_16x16x32_bf16 v[12:15], v[52:55], v[40:43], v[12:15]
    v_mfma_f32_16x16x32_bf16 v[12:15], v[52:55], v[44:47], v[12:15]
    v_mfma_f32_16x16x32_bf16 v[12:15], v[52:55], v[48:51], v[12:15]
    v_xor_b32 v8, v39, v2
    v_bitop3_b32 v8, v8, v43, v2 bitop3:0xf6
    v_bitop3_b32 v8, v8, v47, v2 bitop3:0xf6
    v_bitop3_b32 v8, v8, v51, v2 bitop3:0xf6
    v_cmp_lt_u32 vcc, 0xffff, v8
    s_nop 0
    s_cbranch_vccz L_ok_39
    s_cmp_eq_u32 s53, 0
    s_cbranch_scc1 L_ok_39
    s_sub_u32 s53, s53, 1
    s_branch L_kv_38
L_ok_39:
    s_mov_b32 vcc_lo, 0xffff0000
    s_mov_b32 exec_hi, 0
    v_cndmask_b32 v15, v15, v2, vcc
    v_cvt_pk_bf16_f32 v10, v12, v13
    v_cvt_pk_bf16_f32 v11, v14, v15
    buffer_store_dwordx2 v[10:11], v9, s[4:7], s55 offen sc1
    s_mov_b32 exec_hi, -1
L_nored_37:
    s_lshl_b32 s54, s64, 11
    s_add_u32 s54, s54, s17
    s_add_u32 s54, s54, 65536
    buffer_load_dwordx4 v[56:59], v1, s[4:7], s54 offen sc1
    buffer_load_dwordx4 v[60:63], v1, s[4:7], s54 offen offset:1024 sc1
    v_mov_b32 v20, -1
    v_mov_b32 v21, -1
    v_mov_b32 v22, -1
    v_mov_b32 v23, -1
    s_add_u32 s62, s19, 14336
    s_cmp_eq_u32 s52, 0
    s_cbranch_scc0 L_slow_40
    buffer_store_dwordx4 v[20:23], v1, s[4:7], s19 offen
    buffer_store_dwordx4 v[20:23], v1, s[4:7], s62 offen
    buffer_store_dword v20, v1, s[4:7], s25 offen
    s_branch L_done_41
L_slow_40:
    buffer_store_dwordx4 v[20:23], v1, s[4:7], s19 offen sc1
    buffer_store_dwordx4 v[20:23], v1, s[4:7], s62 offen sc1
    buffer_store_dword v20, v1, s[4:7], s25 offen sc1
L_done_41:
    s_lshl_b32 s56, s49, 12
    s_add_u32 s56, s56, 1900544
    v_add_u32 v9, 89600, v1
    s_cmp_lg_u32 s50, 0
    s_cbranch_scc1 L_nokf_42
    s_sleep 11
L_kf_43:
    buffer_load_dwordx4 v[36:39], v1, s[4:7], s56 offen offset:0 sc1
    buffer_load_dwordx4 v[40:43], v1, s[4:7], s56 offen offset:1024 sc1
    buffer_load_dwordx4 v[44:47], v1, s[4:7], s56 offen offset:2048 sc1
    buffer_load_dwordx4 v[48:51], v1, s[4:7], s56 offen offset:3072 sc1
    s_waitcnt vmcnt(3)
    ds_write_b128 v9, v[36:39] offset:0
    s_waitcnt vmcnt(2)
    ds_write_b128 v9, v[40:43] offset:1024
    s_waitcnt vmcnt(1)
    ds_write_b128 v9, v[44:47] offset:2048
    s_waitcnt vmcnt(0)
    ds_write_b128 v9, v[48:51] offset:3072
    v_xor_b32 v8, v39, v2
    v_bitop3_b32 v8, v8, v43, v2 bitop3:0xf6
    v_bitop3_b32 v8, v8, v47, v2 bitop3:0xf6
    v_bitop3_b32 v8, v8, v51, v2 bitop3:0xf6
    v_cmp_lt_u32 vcc, 0xffff, v8
    s_nop 0
    s_cbranch_vccz L_ok_44
    s_cmp_eq_u32 s53, 0
    s_cbranch_scc1 L_ok_44
    s_sub_u32 s53, s53, 1
    s_branch L_kf_43
L_ok_44:
L_nokf_42:
    s_waitcnt vmcnt(0) lgkmcnt(0)
    s_barrier
L_g2_45:
    v_lshlrev_b32 v20, 16, v56
    v_and_b32 v21, 0xffff0000, v56
    v_lshlrev_b32 v22, 16, v57
    v_and_b32 v23, 0xffff0000, v57
    v_lshlrev_b32 v24, 16, v58
    v_and_b32 v25, 0xffff0000, v58
    v_lshlrev_b32 v26, 16, v59
    v_and_b32 v27, 0xffff0000, v59
    v_lshlrev_b32 v28, 16, v60
    v_and_b32 v29, 0xffff0000, v60
    v_lshlrev_b32 v30, 16, v61
    v_and_b32 v31, 0xffff0000, v61
    v_lshlrev_b32 v32, 16, v62
    v_and_b32 v33, 0xffff0000, v62
    v_lshlrev_b32 v34, 16, v63
    v_and_b32 v35, 0xffff0000, v63
    v_add_u32 v8, 93696, v1
    v_add_u32 v9, 126464, v1
    s_bitcmp1_b32 s49, 0
    s_cselect_b32 s3, 0, 14336
    v_add_u32 v10, s3, v9
    s_cmp_eq_u32 s65, 0
    s_cselect_b32 s57, 268435456, s19
    s_cselect_b32 s62, 268435456, s62
    s_cselect_b32 s71, 268435456, s25
    s_add_u32 s54, s24, 6291456
    s_add_u32 s55, s24, 7208960
    s_cmp_eq_u32 s59, 0
    s_cselect_b32 s54, 268435456, s54
    s_cselect_b32 s55, 268435456, s55
    v_mov_b32 v11, 0
    v_mov_b32 v12, 60160
    s_barrier
    ds_write_b32 v12, v11
    ds_read_b128 v[36:39], v8 offset:0
    ds_read_b128 v[40:43], v8 offset:8192
    ds_read_b128 v[44:47], v8 offset:16384
    ds_read_b128 v[48:51], v8 offset:24576
    ds_read_b128 v[52:55], v8 offset:1024
    ds_read_b128 v[56:59], v8 offset:9216
    s_waitcnt lgkmcnt(5)
    v_mfma_f32_32x32x16_bf16 v[20:35], v[80:83], v[36:39], v[20:35]
    v_bitop3_b32 v11, v11, v39, v2 bitop3:0xf6
    ds_read_b128 v[60:63], v8 offset:17408
    s_waitcnt lgkmcnt(5)
    v_mfma_f32_32x32x16_bf16 v[20:35], v[112:115], v[40:43], v[20:35]
    v_bitop3_b32 v11, v11, v43, v2 bitop3:0xf6
    ds_read_b128 v[64:67], v8 offset:25600
    s_waitcnt lgkmcnt(5)
    v_mfma_f32_32x32x16_bf16 v[20:35], v[144:147], v[44:47], v[20:35]
    v_bitop3_b32 v11, v11, v47, v2 bitop3:0xf6
    s_barrier
    ds_read_b128 v[36:39], v8 offset:2048
    s_waitcnt lgkmcnt(5)
    v_mfma_f32_32x32x16_bf16 v[20:35], v[176:179], v[48:51], v[20:35]
    v_bitop3_b32 v11, v11, v51, v2 bitop3:0xf6
    ds_read_b128 v[40:43], v8 offset:10240
    s_waitcnt lgkmcnt(5)
    v_mfma_f32_32x32x16_bf16 v[20:35], v[84:87], v[52:55], v[20:35]
    v_bitop3_b32 v11, v11, v55, v2 bitop3:0xf6
    ds_read_b128 v[44:47], v8 offset:18432
    s_waitcnt lgkmcnt(5)
    v_mfma_f32_32x32x16_bf16 v[20:35], v[116:119], v[56:59], v[20:35]
    v_bitop3_b32 v11, v11, v59, v2 bitop3:0xf6
    ds_read_b128 v[48:51], v8 offset:26624
    s_waitcnt lgkmcnt(5)
    v_mfma_f32_32x32x16_bf16 v[20:35], v[148:151], v[60:63], v[20:35]
    v_bitop3_b32 v11, v11, v63, v2 bitop3:0xf6
    ds_read_b128 v[52:55], v8 offset:3072
    s_waitcnt lgkmcnt(5)
    v_mfma_f32_32x32x16_bf16 v[20:35], v[180:183], v[64:67], v[20:35]
    v_bitop3_b32 v11, v11, v67, v2 bitop3:0xf6
    ds_read_b128 v[56:59], v8 offset:11264
    s_waitcnt lgkmcnt(5)
    v_mfma_f32_32x32x16_bf16 v[20:35], v[88:91], v[36:39], v[20:35]
    v_bitop3_b32 v11, v11, v39, v2 bitop3:0xf6
    ds_read_b128 v[60:63], v8 offset:19456
    s_waitcnt lgkmcnt(5)
    v_mfma_f32_32x32x16_bf16 v[20:35], v[120:123], v[40:43], v[20:35]
    v_bitop3_b32 v11, v11, v43, v2 bitop3:0xf6
    ds_read_b128 v[64:67], v8 offset:27648
    s_waitcnt lgkmcnt(5)
    v_mfma_f32_32x32x16_bf16 v[20:35], v[152:155], v[44:47], v[20:35]
    v_bitop3_b32 v11, v11, v47, v2 bitop3:0xf6
    s_barrier
    ds_read_b128 v[36:39], v8 offset:4096
    s_waitcnt lgkmcnt(5)
    v_mfma_f32_32x32x16_bf16 v[20:35], v[184:187], v[48:51], v[20:35]
    v_bitop3_b32 v11, v11, v51, v2 bitop3:0xf6
    ds_read_b128 v[40:43], v8 offset:12288
    s_waitcnt lgkmcnt(5)
    v_mfma_f32_32x32x16_bf16 v[20:35], v[92:95], v[52:55], v[20:35]
    v_bitop3_b32 v11, v11, v55, v2 bitop3:0xf6
    ds_read_b128 v[44:47], v8 offset:20480
    s_waitcnt lgkmcnt(5)
    v_mfma_f32_32x32x16_bf16 v[20:35], v[124:127], v[56:59], v[20:35]
    v_bitop3_b32 v11, v11, v59, v2 bitop3:0xf6
    ds_read_b128 v[48:51], v8 offset:28672
    s_waitcnt lgkmcnt(5)
    v_mfma_f32_32x32x16_bf16 v[20:35], v[156:159], v[60:63], v[20:35]
    v_bitop3_b32 v11, v11, v63, v2 bitop3:0xf6
    ds_read_b128 v[52:55], v8 offset:5120
    s_waitcnt lgkmcnt(5)
    v_mfma_f32_32x32x16_bf16 v[20:35], v[188:191], v[64:67], v[20:35]
    v_bitop3_b32 v11, v11, v67, v2 bitop3:0xf6
    ds_read_b128 v[56:59], v8 offset:13312
    s_waitcnt lgkmcnt(5)
    v_mfma_f32_32x32x16_bf16 v[20:35], v[96:99], v[36:39], v[20:35]
    v_bitop3_b32 v11, v11, v39, v2 bitop3:0xf6
    ds_read_b128 v[60:63], v8 offset:21504
    s_waitcnt lgkmcnt(5)
    v_mfma_f32_32x32x16_bf16 v[20:35], v[128:131], v[40:43], v[20:35]
    v_bitop3_b32 v11, v11, v43, v2 bitop3:0xf6
    ds_read_b128 v[64:67], v8 offset:29696
    s_waitcnt lgkmcnt(5)
    v_mfma_f32_32x32x16_bf16 v[20:35], v[160:163], v[44:47], v[20:35]
    v_bitop3_b32 v11, v11, v47, v2 bitop3:0xf6
    s_barrier
    ds_read_b128 v[36:39], v8 offset:6144
    s_waitcnt lgkmcnt(5)
    v_mfma_f32_32x32x16_bf16 v[20:35], v[192:195], v[48:51], v[20:35]
    v_bitop3_b32 v11, v11, v51, v2 bitop3:0xf6
    ds_read_b128 v[40:43], v8 offset:14336
    s_waitcnt lgkmcnt(5)
    v_mfma_f32_32x32x16_bf16 v[20:35], v[100:103], v[52:55], v[20:35]
    v_bitop3_b32 v11, v11, v55, v2 bitop3:0xf6
    ds_read_b128 v[44:47], v8 offset:22528
    s_waitcnt lgkmcnt(5)
    v_mfma_f32_32x32x16_bf16 v[20:35], v[132:135], v[56:59], v[20:35]
    v_bitop3_b32 v11, v11, v59, v2 bitop3:0xf6
    ds_read_b128 v[48:51], v8 offset:30720
    s_waitcnt lgkmcnt(5)
    v_mfma_f32_32x32x16_bf16 v[20:35], v[164:167], v[60:63], v[20:35]
    v_bitop3_b32 v11, v11, v63, v2 bitop3:0xf6
    ds_read_b128 v[52:55], v8 offset:7168
    s_waitcnt lgkmcnt(5)
    v_mfma_f32_32x32x16_bf16 v[20:35], v[196:199], v[64:67], v[20:35]
    v_bitop3_b32 v11, v11, v67, v2 bitop3:0xf6
    ds_read_b128 v[56:59], v8 offset:15360
    s_waitcnt lgkmcnt(5)
    v_mfma_f32_32x32x16_bf16 v[20:35], v[104:107], v[36:39], v[20:35]
    v_bitop3_b32 v11, v11, v39, v2 bitop3:0xf6
    ds_read_b128 v[60:63], v8 offset:23552
    s_waitcnt lgkmcnt(5)
    v_mfma_f32_32x32x16_bf16 v[20:35], v[136:139], v[40:43], v[20:35]
    v_bitop3_b32 v11, v11, v43, v2 bitop3:0xf6
    ds_read_b128 v[64:67], v8 offset:31744
    s_waitcnt lgkmcnt(5)
    v_mfma_f32_32x32x16_bf16 v[20:35], v[168:171], v[44:47], v[20:35]
    v_bitop3_b32 v11, v11, v47, v2 bitop3:0xf6
    s_waitcnt lgkmcnt(4)
    v_mfma_f32_32x32x16_bf16 v[20:35], v[200:203], v[48:51], v[20:35]
    v_bitop3_b32 v11, v11, v51, v2 bitop3:0xf6
    s_waitcnt lgkmcnt(3)
    v_mfma_f32_32x32x16_bf16 v[20:35], v[108:111], v[52:55], v[20:35]
    v_bitop3_b32 v11, v11, v55, v2 bitop3:0xf6
    s_waitcnt lgkmcnt(2)
    v_mfma_f32_32x32x16_bf16 v[20:35], v[140:143], v[56:59], v[20:35]
    v_bitop3_b32 v11, v11, v59, v2 bitop3:0xf6
    s_waitcnt lgkmcnt(1)
    v_mfma_f32_32x32x16_bf16 v[20:35], v[172:175], v[60:63], v[20:35]
    v_bitop3_b32 v11, v11, v63, v2 bitop3:0xf6
    s_waitcnt lgkmcnt(0)
    v_mfma_f32_32x32x16_bf16 v[20:35], v[204:207], v[64:67], v[20:35]
    v_bitop3_b32 v11, v11, v67, v2 bitop3:0xf6
    v_cmp_lt_u32 vcc, 0xffff, v11
    s_nop 0
    s_cbranch_vccz L_ok_46
    s_cmp_eq_u32 s53, 0
    s_cbranch_scc1 L_ok_46
    s_sub_u32 s53, s53, 1
    v_mov_b32 v12, 60160
    ds_write_b32 v12, v12
    s_waitcnt lgkmcnt(0)
    s_barrier
    s_lshl_b32 s54, s64, 11
    s_add_u32 s54, s54, s17
    s_add_u32 s54, s54, 65536
    buffer_load_dwordx4 v[56:59], v1, s[4:7], s54 offen sc1
    buffer_load_dwordx4 v[60:63], v1, s[4:7], s54 offen offset:1024 sc1
    s_waitcnt vmcnt(0)
    s_branch L_g2_45
L_ok_46:
    s_nop 7
    v_pk_add_f32 v[36:37], v[20:21], v[24:25]
    v_pk_add_f32 v[38:39], v[22:23], v[26:27]
    v_pk_add_f32 v[40:41], v[28:29], v[32:33]
    v_pk_add_f32 v[42:43], v[30:31], v[34:35]
    v_pk_add_f32 v[44:45], v[20:21], v[24:25] neg_lo:[0,1] neg_hi:[0,1]
    v_pk_add_f32 v[46:47], v[22:23], v[26:27] neg_lo:[0,1] neg_hi:[0,1]
    v_pk_add_f32 v[48:49], v[28:29], v[32:33] neg_lo:[0,1] neg_hi:[0,1]
    v_pk_add_f32 v[50:51], v[30:31], v[34:35] neg_lo:[0,1] neg_hi:[0,1]
    v_cvt_pk_bf16_f32 v52, v36, v37
    v_cvt_pk_bf16_f32 v53, v38, v39
    v_cvt_pk_bf16_f32 v54, v40, v41
    v_cvt_pk_bf16_f32 v55, v42, v43
    v_cvt_pk_bf16_f32 v56, v44, v45
    v_cvt_pk_bf16_f32 v57, v46, v47
    v_cvt_pk_bf16_f32 v58, v48, v49
    v_cvt_pk_bf16_f32 v59, v50, v51
    s_cmp_eq_u32 s52, 0
    s_cbranch_scc0 L_slow_47
    buffer_store_dwordx4 v[52:55], v1, s[4:7], s57 offen
    buffer_store_dwordx4 v[56:59], v1, s[4:7], s62 offen
    s_branch L_done_48
L_slow_47:
    buffer_store_dwordx4 v[52:55], v1, s[4:7], s57 offen sc1
    buffer_store_dwordx4 v[56:59], v1, s[4:7], s62 offen sc1
L_done_48:
    s_barrier
    v_pk_add_f32 v[14:15], v[36:37], v[38:39]
    v_pk_mul_f32 v[16:17], v[20:21], v[20:21]
    v_pk_fma_f32 v[16:17], v[22:23], v[22:23], v[16:17]
    v_pk_add_f32 v[14:15], v[14:15], v[40:41]
    v_pk_fma_f32 v[16:17], v[24:25], v[24:25], v[16:17]
    v_pk_add_f32 v[14:15], v[14:15], v[42:43]
    v_pk_fma_f32 v[16:17], v[26:27], v[26:27], v[16:17]
    v_pk_fma_f32 v[16:17], v[28:29], v[28:29], v[16:17]
    v_pk_fma_f32 v[16:17], v[30:31], v[30:31], v[16:17]
    v_pk_fma_f32 v[16:17], v[32:33], v[32:33], v[16:17]
    v_pk_fma_f32 v[16:17], v[34:35], v[34:35], v[16:17]
    v_add_f32 v14, v14, v15
    v_add_f32 v16, v16, v17
    s_nop 1
    v_permlane32_swap_b32 v14, v16
    v_add_f32 v14, v14, v16
    s_cmp_eq_u32 s52, 0
    s_cbranch_scc0 L_slow_49
    buffer_store_dword v14, v1, s[4:7], s71 offen
    s_branch L_done_50
L_slow_49:
    buffer_store_dword v14, v1, s[4:7], s71 offen sc1
L_done_50:
    s_and_b32 s56, s36, -16384
    s_and_b32 s3, s49, 1
    s_lshl_b32 s3, s3, 6
    s_add_u32 s56, s56, s3
    s_add_u32 s56, s56, 6291456
    s_add_u32 s57, s56, 8192
    v_add_u32 v11, 151040, v1
    s_barrier
    ds_read_b128 v[36:39], v9 offset:0
    ds_read_b128 v[40:43], v9 offset:5120
    ds_read_b128 v[44:47], v9 offset:10240
    ds_read_b128 v[48:51], v9 offset:1024
    ds_read_b128 v[52:55], v9 offset:6144
    ds_read_b128 v[56:59], v9 offset:11264
    s_waitcnt lgkmcnt(5)
    v_mfma_f32_32x32x16_bf16 v[20:35], v[36:39], a[0:3], 0
    ds_read_b128 v[60:63], v9 offset:2048
    s_waitcnt lgkmcnt(5)
    v_mfma_f32_32x32x16_bf16 v[20:35], v[40:43], a[20:23], v[20:35]
    ds_read_b128 v[64:67], v9 offset:7168
    s_waitcnt lgkmcnt(5)
    v_mfma_f32_32x32x16_bf16 v[20:35], v[44:47], a[40:43], v[20:35]
    ds_read_b128 v[36:39], v9 offset:12288
    s_waitcnt lgkmcnt(5)
    v_mfma_f32_32x32x16_bf16 v[20:35], v[48:51], a[4:7], v[20:35]
    ds_read_b128 v[40:43], v9 offset:3072
    s_waitcnt lgkmcnt(5)
    v_mfma_f32_32x32x16_bf16 v[20:35], v[52:55], a[24:27], v[20:35]
    ds_read_b128 v[44:47], v9 offset:8192
    s_waitcnt lgkmcnt(5)
    v_mfma_f32_32x32x16_bf16 v[20:35], v[56:59], a[44:47], v[20:35]
    ds_read_b128 v[48:51], v9 offset:13312
    s_waitcnt lgkmcnt(5)
    v_mfma_f32_32x32x16_bf16 v[20:35], v[60:63], a[8:11], v[20:35]
    ds_read_b128 v[52:55], v9 offset:4096
    s_waitcnt lgkmcnt(5)
    v_mfma_f32_32x32x16_bf16 v[20:35], v[64:67], a[28:31], v[20:35]
    ds_read_b128 v[56:59], v9 offset:9216
    s_waitcnt lgkmcnt(5)
    v_mfma_f32_32x32x16_bf16 v[20:35], v[36:39], v[68:71], v[20:35]
    ds_read_b128 v[60:63], v10
    s_waitcnt lgkmcnt(5)
    v_mfma_f32_32x32x16_bf16 v[20:35], v[40:43], a[12:15], v[20:35]
    s_waitcnt lgkmcnt(4)
    v_mfma_f32_32x32x16_bf16 v[20:35], v[44:47], a[32:35], v[20:35]
    s_waitcnt lgkmcnt(3)
    v_mfma_f32_32x32x16_bf16 v[20:35], v[48:51], v[72:75], v[20:35]
    s_waitcnt lgkmcnt(2)
    v_mfma_f32_32x32x16_bf16 v[20:35], v[52:55], a[16:19], v[20:35]
    s_waitcnt lgkmcnt(1)
    v_mfma_f32_32x32x16_bf16 v[20:35], v[56:59], a[36:39], v[20:35]
    s_waitcnt lgkmcnt(0)
    v_mfma_f32_32x32x16_bf16 v[20:35], v[60:63], v[76:79], v[20:35]
    s_barrier
    ds_read_b128 v[12:15], v11
    ds_read_b128 v[16:19], v11 offset:1024
    s_nop 8
    v_cvt_pk_bf16_f32 v36, v20, v21
    v_cvt_pk_bf16_f32 v37, v22, v23
    v_cvt_pk_bf16_f32 v38, v24, v25
    v_cvt_pk_bf16_f32 v39, v26, v27
    v_cvt_pk_bf16_f32 v40, v28, v29
    v_cvt_pk_bf16_f32 v41, v30, v31
    v_cvt_pk_bf16_f32 v42, v32, v33
    v_cvt_pk_bf16_f32 v43, v34, v35
    s_waitcnt lgkmcnt(0)
    v_mfma_f32_32x32x16_bf16 v[44:59], v[36:39], v[12:15], 0
    v_mfma_f32_32x32x16_bf16 v[44:59], v[40:43], v[16:19], v[44:59]
    v_and_b32 v8, -64, v3
    v_add_u32 v8, v8, v3
    v_lshrrev_b32 v9, 5, v3
    v_lshlrev_b32 v9, 4, v9
    v_and_b32 v10, 1, v0
    v_lshl_add_u32 v9, v10, 12, v9
    v_add_u32 v9, 142848, v9
    s_nop 4
    v_cvt_pk_bf16_f32 v20, v44, v45
    v_cvt_pk_bf16_f32 v24, v52, v53
    v_cvt_pk_bf16_f32 v21, v46, v47
    v_cvt_pk_bf16_f32 v25, v54, v55
    v_cvt_pk_bf16_f32 v22, v48, v49
    v_cvt_pk_bf16_f32 v26, v56, v57
    v_cvt_pk_bf16_f32 v23, v50, v51
    v_cvt_pk_bf16_f32 v27, v58, v59
    v_permlane16_swap_b32 v20, v24
    v_permlane16_swap_b32 v21, v25
    v_permlane16_swap_b32 v22, v26
    v_permlane16_swap_b32 v23, v27
    buffer_store_dwordx4 v[20:23], v7, s[4:7], s54 offen sc1
    buffer_store_dwordx4 v[24:27], v7, s[4:7], s55 offen sc1
    s_barrier
    s_cmp_ge_u32 s49, 14
    s_cbranch_scc1 L_noc_51
    s_sleep 16
L_c_52:
    buffer_load_dwordx4 v[36:39], v8, s[4:7], s56 offen sc1
    buffer_load_dwordx4 v[40:43], v8, s[4:7], s57 offen sc1
    s_waitcnt vmcnt(1)
    ds_write_b128 v9, v[36:39]
    s_waitcnt vmcnt(0)
    ds_write_b128 v9, v[40:43] offset:2048
    v_max_u32 v10, v36, v40
    v_cmp_eq_u32 vcc, -1, v10
    s_nop 0
    s_cbranch_vccz L_ok_53
    s_cmp_eq_u32 s53, 0
    s_cbranch_scc1 L_ok_53
    s_sub_u32 s53, s53, 1
    s_branch L_c_52
L_ok_53:
    s_waitcnt lgkmcnt(0)
    s_barrier
L_noc_51:
    s_lshl_b32 s54, s2, 2
    s_add_u32 s54, s54, s50
    s_cmp_lg_u32 s54, 0
    s_cbranch_scc1 L_noep_54
    v_mov_b32 v4, s51
    s_mov_b64 exec, 1
    buffer_store_dword v4, v1, s[4:7], 0 offen
    s_mov_b64 exec, -1
L_noep_54:
    s_endpgm
L_P:
    s_mov_b32 exec_lo, 0x11111111
    s_mov_b32 exec_hi, 0x11111111
    buffer_store_dwordx2 v[176:177], v178, s[4:7], s45 offen sc1
    s_mov_b64 exec, -1
    s_add_u32 s54, s57, 256
    s_add_u32 m0, s62, 32768
    s_nop 0
    buffer_load_dwordx4 v26, s[8:11], s54 offen offset:0 lds
    buffer_load_dwordx4 v27, s[8:11], s54 offen offset:1024 lds
    buffer_load_dwordx4 v28, s[8:11], s54 offen offset:2048 lds
    buffer_load_dwordx4 v29, s[8:11], s54 offen offset:3072 lds
    s_add_u32 s54, s57, 384
    s_add_u32 m0, s62, 36864
    s_nop 0
    buffer_load_dwordx4 v26, s[8:11], s54 offen offset:0 lds
    buffer_load_dwordx4 v27, s[8:11], s54 offen offset:1024 lds
    buffer_load_dwordx4 v28, s[8:11], s54 offen offset:2048 lds
    buffer_load_dwordx4 v29, s[8:11], s54 offen offset:3072 lds
    s_waitcnt vmcnt(13)
    ds_read_b128 v[32:35], v18 offset:0
    ds_read_b128 v[36:39], v19 offset:0
    ds_read_b128 v[40:43], v20 offset:0
    ds_read_b128 v[44:47], v21 offset:0
    s_barrier
    ds_read_b64_tr_b16 a[0:1], v4 offset:0
    ds_read_b64_tr_b16 a[2:3], v4 offset:256
    ds_read_b64_tr_b16 a[4:5], v4 offset:28800
    ds_read_b64_tr_b16 a[6:7], v4 offset:29056
    ds_read_b64_tr_b16 a[8:9], v5 offset:0
    ds_read_b64_tr_b16 a[10:11], v5 offset:256
    ds_read_b64_tr_b16 a[12:13], v5 offset:28800
    ds_read_b64_tr_b16 a[14:15], v5 offset:29056
    ds_read_b64_tr_b16 a[16:17], v6 offset:0
    ds_read_b64_tr_b16 a[18:19], v6 offset:256
    ds_read_b64_tr_b16 a[20:21], v6 offset:28800
    ds_read_b64_tr_b16 a[22:23], v6 offset:29056
    ds_read_b64_tr_b16 a[24:25], v7 offset:0
    ds_read_b64_tr_b16 a[26:27], v7 offset:256
    ds_read_b64_tr_b16 a[28:29], v7 offset:28800
    ds_read_b64_tr_b16 a[30:31], v7 offset:29056
    s_waitcnt lgkmcnt(12)
    v_mfma_f32_32x32x16_bf16 v[144:159], a[0:3], v[32:35], 0
    s_waitcnt vmcnt(9)
    ds_read_b128 v[48:51], v18 offset:4096
    ds_read_b128 v[52:55], v19 offset:4096
    ds_read_b128 v[56:59], v20 offset:4096
    s_waitcnt lgkmcnt(11)
    v_mfma_f32_32x32x16_bf16 v[160:175], a[4:7], v[32:35], 0
    ds_read_b128 v[60:63], v21 offset:4096
    ds_read_b64_tr_b16 v[176:177], v4 offset:4096
    ds_read_b64_tr_b16 v[178:179], v4 offset:4352
    ds_read_b64_tr_b16 v[180:181], v4 offset:32896
    s_add_u32 s54, s57, 512
    s_add_u32 m0, s62, 0
    s_nop 0
    buffer_load_dwordx4 v26, s[8:11], s54 offen offset:0 lds
    s_waitcnt lgkmcnt(11)
    v_mfma_f32_32x32x16_bf16 v[144:159], a[8:11], v[36:39], v[144:159]
    ds_read_b64_tr_b16 v[182:183], v4 offset:33152
    ds_read_b64_tr_b16 v[184:185], v5 offset:4096
    ds_read_b64_tr_b16 v[186:187], v5 offset:4352
    ds_read_b64_tr_b16 v[188:189], v5 offset:32896
    s_waitcnt lgkmcnt(11)
    v_mfma_f32_32x32x16_bf16 v[160:175], a[12:15], v[36:39], v[160:175]
    ds_read_b64_tr_b16 v[190:191], v5 offset:33152
    ds_read_b64_tr_b16 v[192:193], v6 offset:4096
    ds_read_b64_tr_b16 v[194:195], v6 offset:4352
    ds_read_b64_tr_b16 v[196:197], v6 offset:32896
    buffer_load_dwordx4 v27, s[8:11], s54 offen offset:1024 lds
    v_mfma_f32_32x32x16_bf16 v[144:159], a[16:19], v[40:43], v[144:159]
    ds_read_b64_tr_b16 v[198:199], v6 offset:33152
    ds_read_b64_tr_b16 v[200:201], v7 offset:4096
    ds_read_b64_tr_b16 v[202:203], v7 offset:4352
    ds_read_b64_tr_b16 v[204:205], v7 offset:32896
    v_mfma_f32_32x32x16_bf16 v[160:175], a[20:23], v[40:43], v[160:175]
    ds_read_b64_tr_b16 v[206:207], v7 offset:33152
    buffer_load_dwordx4 v28, s[8:11], s54 offen offset:2048 lds
    v_mfma_f32_32x32x16_bf16 v[144:159], a[24:27], v[44:47], v[144:159]
    v_mfma_f32_32x32x16_bf16 v[160:175], a[28:31], v[44:47], v[160:175]
    buffer_load_dwordx4 v29, s[8:11], s54 offen offset:3072 lds
    s_waitcnt lgkmcnt(0)
    v_mfma_f32_32x32x16_bf16 v[144:159], v[176:179], v[48:51], v[144:159]
    s_barrier
    s_waitcnt vmcnt(8)
    ds_read_b128 v[64:67], v18 offset:32768
    ds_read_b128 v[68:71], v19 offset:32768
    v_mfma_f32_32x32x16_bf16 v[160:175], v[180:183], v[48:51], v[160:175]
    ds_read_b128 v[72:75], v20 offset:32768
    ds_read_b128 v[76:79], v21 offset:32768
    ds_read_b64_tr_b16 a[0:1], v4 offset:8192
    ds_read_b64_tr_b16 a[2:3], v4 offset:8448
    s_add_u32 s54, s57, 640
    s_add_u32 m0, s62, 4096
    s_nop 0
    buffer_load_dwordx4 v26, s[8:11], s54 offen offset:0 lds
    v_mfma_f32_32x32x16_bf16 v[144:159], v[184:187], v[52:55], v[144:159]
    ds_read_b64_tr_b16 a[4:5], v4 offset:36992
    ds_read_b64_tr_b16 a[6:7], v4 offset:37248
    ds_read_b64_tr_b16 a[8:9], v5 offset:8192
    ds_read_b64_tr_b16 a[10:11], v5 offset:8448
    v_mfma_f32_32x32x16_bf16 v[160:175], v[188:191], v[52:55], v[160:175]
    ds_read_b64_tr_b16 a[12:13], v5 offset:36992
    ds_read_b64_tr_b16 a[14:15], v5 offset:37248
    ds_read_b64_tr_b16 a[16:17], v6 offset:8192
    ds_read_b64_tr_b16 a[18:19], v6 offset:8448
    buffer_load_dwordx4 v27, s[8:11], s54 offen offset:1024 lds
    v_mfma_f32_32x32x16_bf16 v[144:159], v[192:195], v[56:59], v[144:159]
    ds_read_b64_tr_b16 a[20:21], v6 offset:36992
    ds_read_b64_tr_b16 a[22:23], v6 offset:37248
    ds_read_b64_tr_b16 a[24:25], v7 offset:8192
    ds_read_b64_tr_b16 a[26:27], v7 offset:8448
    v_mfma_f32_32x32x16_bf16 v[160:175], v[196:199], v[56:59], v[160:175]
    ds_read_b64_tr_b16 a[28:29], v7 offset:36992
    ds_read_b64_tr_b16 a[30:31], v7 offset:37248
    buffer_load_dwordx4 v28, s[8:11], s54 offen offset:2048 lds
    v_mfma_f32_32x32x16_bf16 v[144:159], v[200:203], v[60:63], v[144:159]
    v_mfma_f32_32x32x16_bf16 v[160:175], v[204:207], v[60:63], v[160:175]
    buffer_load_dwordx4 v29, s[8:11], s54 offen offset:3072 lds
    s_waitcnt lgkmcnt(0)
    v_mfma_f32_32x32x16_bf16 v[144:159], a[0:3], v[64:67], v[144:159]
    s_waitcnt vmcnt(8)
    ds_read_b128 v[80:83], v18 offset:36864
    ds_read_b128 v[84:87], v19 offset:36864
    ds_read_b128 v[88:91], v20 offset:36864
    v_mfma_f32_32x32x16_bf16 v[160:175], a[4:7], v[64:67], v[160:175]
    ds_read_b128 v[92:95], v21 offset:36864
    ds_read_b64_tr_b16 v[176:177], v4 offset:12288
    ds_read_b64_tr_b16 v[178:179], v4 offset:12544
    ds_read_b64_tr_b16 v[180:181], v4 offset:41088
    s_add_u32 s54, s57, 768
    s_add_u32 m0, s62, 32768
    s_nop 0
    buffer_load_dwordx4 v26, s[8:11], s54 offen offset:0 lds
    v_mfma_f32_32x32x16_bf16 v[144:159], a[8:11], v[68:71], v[144:159]
    ds_read_b64_tr_b16 v[182:183], v4 offset:41344
    ds_read_b64_tr_b16 v[184:185], v5 offset:12288
    ds_read_b64_tr_b16 v[186:187], v5 offset:12544
    ds_read_b64_tr_b16 v[188:189], v5 offset:41088
    v_mfma_f32_32x32x16_bf16 v[160:175], a[12:15], v[68:71], v[160:175]
    ds_read_b64_tr_b16 v[190:191], v5 offset:41344
    ds_read_b64_tr_b16 v[192:193], v6 offset:12288
    ds_read_b64_tr_b16 v[194:195], v6 offset:12544
    ds_read_b64_tr_b16 v[196:197], v6 offset:41088
    buffer_load_dwordx4 v27, s[8:11], s54 offen offset:1024 lds
    v_mfma_f32_32x32x16_bf16 v[144:159], a[16:19], v[72:75], v[144:159]
    ds_read_b64_tr_b16 v[198:199], v6 offset:41344
    ds_read_b64_tr_b16 v[200:201], v7 offset:12288
    ds_read_b64_tr_b16 v[202:203], v7 offset:12544
    ds_read_b64_tr_b16 v[204:205], v7 offset:41088
    v_mfma_f32_32x32x16_bf16 v[160:175], a[20:23], v[72:75], v[160:175]
    ds_read_b64_tr_b16 v[206:207], v7 offset:41344
    buffer_load_dwordx4 v28, s[8:11], s54 offen offset:2048 lds
    v_mfma_f32_32x32x16_bf16 v[144:159], a[24:27], v[76:79], v[144:159]
    buffer_load_dwordx2 v[24:25], v16, s[4:7], s44 offen sc1
    v_mfma_f32_32x32x16_bf16 v[160:175], a[28:31], v[76:79], v[160:175]
    buffer_load_dwordx4 v29, s[8:11], s54 offen offset:3072 lds
    s_waitcnt lgkmcnt(0)
    v_mfma_f32_32x32x16_bf16 v[144:159], v[176:179], v[80:83], v[144:159]
    s_barrier
    s_waitcnt vmcnt(9)
    ds_read_b128 v[96:99], v18 offset:0
    ds_read_b128 v[100:103], v19 offset:0
    v_mfma_f32_32x32x16_bf16 v[160:175], v[180:183], v[80:83], v[160:175]
    ds_read_b128 v[104:107], v20 offset:0
    ds_read_b128 v[108:111], v21 offset:0
    ds_read_b64_tr_b16 a[0:1], v4 offset:16384
    ds_read_b64_tr_b16 a[2:3], v4 offset:16640
    v_mfma_f32_32x32x16_bf16 v[144:159], v[184:187], v[84:87], v[144:159]
    ds_read_b64_tr_b16 a[4:5], v4 offset:45184
    ds_read_b64_tr_b16 a[6:7], v4 offset:45440
    ds_read_b64_tr_b16 a[8:9], v5 offset:16384
    ds_read_b64_tr_b16 a[10:11], v5 offset:16640
    v_mfma_f32_32x32x16_bf16 v[160:175], v[188:191], v[84:87], v[160:175]
    ds_read_b64_tr_b16 a[12:13], v5 offset:45184
    ds_read_b64_tr_b16 a[14:15], v5 offset:45440
    ds_read_b64_tr_b16 a[16:17], v6 offset:16384
    ds_read_b64_tr_b16 a[18:19], v6 offset:16640
    v_mfma_f32_32x32x16_bf16 v[144:159], v[192:195], v[88:91], v[144:159]
    ds_read_b64_tr_b16 a[20:21], v6 offset:45184
    ds_read_b64_tr_b16 a[22:23], v6 offset:45440
    ds_read_b64_tr_b16 a[24:25], v7 offset:16384
    ds_read_b64_tr_b16 a[26:27], v7 offset:16640
    v_mfma_f32_32x32x16_bf16 v[160:175], v[196:199], v[88:91], v[160:175]
    ds_read_b64_tr_b16 a[28:29], v7 offset:45184
    ds_read_b64_tr_b16 a[30:31], v7 offset:45440
    v_mfma_f32_32x32x16_bf16 v[144:159], v[200:203], v[92:95], v[144:159]
    v_mfma_f32_32x32x16_bf16 v[160:175], v[204:207], v[92:95], v[160:175]
    s_waitcnt lgkmcnt(0)
    v_mfma_f32_32x32x16_bf16 v[144:159], a[0:3], v[96:99], v[144:159]
    s_waitcnt vmcnt(5)
    ds_read_b128 v[112:115], v18 offset:4096
    ds_read_b128 v[116:119], v19 offset:4096
    ds_read_b128 v[120:123], v20 offset:4096
    v_mfma_f32_32x32x16_bf16 v[160:175], a[4:7], v[96:99], v[160:175]
    ds_read_b128 v[124:127], v21 offset:4096
    ds_read_b64_tr_b16 v[176:177], v4 offset:20480
    ds_read_b64_tr_b16 v[178:179], v4 offset:20736
    ds_read_b64_tr_b16 v[180:181], v4 offset:49280
    v_mfma_f32_32x32x16_bf16 v[144:159], a[8:11], v[100:103], v[144:159]
    ds_read_b64_tr_b16 v[182:183], v4 offset:49536
    ds_read_b64_tr_b16 v[184:185], v5 offset:20480
    ds_read_b64_tr_b16 v[186:187], v5 offset:20736
    ds_read_b64_tr_b16 v[188:189], v5 offset:49280
    v_mfma_f32_32x32x16_bf16 v[160:175], a[12:15], v[100:103], v[160:175]
    ds_read_b64_tr_b16 v[190:191], v5 offset:49536
    ds_read_b64_tr_b16 v[192:193], v6 offset:20480
    ds_read_b64_tr_b16 v[194:195], v6 offset:20736
    ds_read_b64_tr_b16 v[196:197], v6 offset:49280
    v_mfma_f32_32x32x16_bf16 v[144:159], a[16:19], v[104:107], v[144:159]
    ds_read_b64_tr_b16 v[198:199], v6 offset:49536
    ds_read_b64_tr_b16 v[200:201], v7 offset:20480
    ds_read_b64_tr_b16 v[202:203], v7 offset:20736
    ds_read_b64_tr_b16 v[204:205], v7 offset:49280
    v_mfma_f32_32x32x16_bf16 v[160:175], a[20:23], v[104:107], v[160:175]
    ds_read_b64_tr_b16 v[206:207], v7 offset:49536
    ds_read_b32 v22, v30 offset:1920
    ds_read_b32 v23, v30 offset:2176
    ds_read_b128 a[32:35], v17 offset:0
    v_mfma_f32_32x32x16_bf16 v[144:159], a[24:27], v[108:111], v[144:159]
    ds_read_b128 a[36:39], v17 offset:1024
    v_mfma_f32_32x32x16_bf16 v[160:175], a[28:31], v[108:111], v[160:175]
    s_waitcnt lgkmcnt(0)
    v_mfma_f32_32x32x16_bf16 v[144:159], v[176:179], v[112:115], v[144:159]
    s_waitcnt vmcnt(0)
    ds_read_b128 v[128:131], v18 offset:32768
    ds_read_b128 v[132:135], v19 offset:32768
    ds_read_b128 v[136:139], v20 offset:32768
    v_mfma_f32_32x32x16_bf16 v[160:175], v[180:183], v[112:115], v[160:175]
    ds_read_b128 v[140:143], v21 offset:32768
    ds_read_b64_tr_b16 a[0:1], v4 offset:24576
    ds_read_b64_tr_b16 a[2:3], v4 offset:24832
    ds_read_b64_tr_b16 a[4:5], v4 offset:53376
    v_mfma_f32_32x32x16_bf16 v[144:159], v[184:187], v[116:119], v[144:159]
    ds_read_b64_tr_b16 a[6:7], v4 offset:53632
    ds_read_b64_tr_b16 a[8:9], v5 offset:24576
    ds_read_b64_tr_b16 a[10:11], v5 offset:24832
    ds_read_b64_tr_b16 a[12:13], v5 offset:53376
    v_mfma_f32_32x32x16_bf16 v[160:175], v[188:191], v[116:119], v[160:175]
    ds_read_b64_tr_b16 a[14:15], v5 offset:53632
    ds_read_b64_tr_b16 a[16:17], v6 offset:24576
    ds_read_b64_tr_b16 a[18:19], v6 offset:24832
    ds_read_b64_tr_b16 a[20:21], v6 offset:53376
    v_mfma_f32_32x32x16_bf16 v[144:159], v[192:195], v[120:123], v[144:159]
    ds_read_b64_tr_b16 a[22:23], v6 offset:53632
    ds_read_b64_tr_b16 a[24:25], v7 offset:24576
    ds_read_b64_tr_b16 a[26:27], v7 offset:24832
    ds_read_b64_tr_b16 a[28:29], v7 offset:53376
    v_mfma_f32_32x32x16_bf16 v[160:175], v[196:199], v[120:123], v[160:175]
    ds_read_b64_tr_b16 a[30:31], v7 offset:53632
    v_add_f32 v22, v22, v23
    ds_write_b32 v30, v22
    v_mfma_f32_32x32x16_bf16 v[144:159], v[200:203], v[124:127], v[144:159]
    v_mfma_f32_32x32x16_bf16 v[160:175], v[204:207], v[124:127], v[160:175]
    s_waitcnt vmcnt(0)
    v_cmp_ne_u32 vcc, s46, v25
    s_nop 0
    s_cbranch_vccz L_rg_11
L_rt_10:
    buffer_load_dwordx2 v[24:25], v16, s[4:7], s44 offen sc1
    s_waitcnt vmcnt(0)
    v_cmp_ne_u32 vcc, s46, v25
    s_nop 0
    s_cbranch_vccz L_ok_12
    s_cmp_eq_u32 s53, 0
    s_cbranch_scc1 L_ok_12
    s_sub_u32 s53, s53, 1
    s_branch L_rt_10
L_ok_12:
L_rg_11:
    s_waitcnt lgkmcnt(0)
    v_mfma_f32_32x32x16_bf16 v[144:159], a[0:3], v[128:131], v[144:159]
    ds_read_b128 v[176:179], v10 offset:128
    ds_read_b128 v[180:183], v10 offset:160
    ds_read_b128 v[184:187], v10 offset:192
    ds_read_b128 v[188:191], v10 offset:224
    v_mfma_f32_32x32x16_bf16 v[160:175], a[4:7], v[128:131], v[160:175]
    ds_read_b128 v[192:195], v10 offset:256
    ds_read_b128 v[196:199], v10 offset:288
    ds_read_b128 v[200:203], v10 offset:320
    ds_read_b128 v[204:207], v10 offset:352
    v_mfma_f32_32x32x16_bf16 v[144:159], a[8:11], v[132:135], v[144:159]
    v_mul_f32 v24, 0x3b124925, v24
    v_mov_b32 v25, v24
    s_nop 1
    v_permlane32_swap_b32 v24, v25
    v_fma_f32 v25, -v24, v24, v25
    v_mfma_f32_32x32x16_bf16 v[160:175], a[12:15], v[132:135], v[160:175]
    v_sub_f32 v12, 0, v24
    v_max_f32 v25, 0, v25
    v_add_f32 v25, 0x3727c5ac, v25
    v_rsq_f32 v14, v25
    v_mfma_f32_32x32x16_bf16 v[144:159], a[16:19], v[136:139], v[144:159]
    v_mfma_f32_32x32x16_bf16 v[160:175], a[20:23], v[136:139], v[160:175]
    v_mfma_f32_32x32x16_bf16 v[144:159], a[24:27], v[140:143], v[144:159]
    v_mfma_f32_32x32x16_bf16 v[160:175], a[28:31], v[140:143], v[160:175]
    s_waitcnt lgkmcnt(4)
    s_nop 9
    v_pk_fma_f32 v[144:145], v[176:177], v[12:13], v[144:145] op_sel_hi:[1,0,1]
    v_pk_fma_f32 v[146:147], v[178:179], v[12:13], v[146:147] op_sel_hi:[1,0,1]
    v_pk_fma_f32 v[148:149], v[180:181], v[12:13], v[148:149] op_sel_hi:[1,0,1]
    v_pk_fma_f32 v[150:151], v[182:183], v[12:13], v[150:151] op_sel_hi:[1,0,1]
    v_pk_fma_f32 v[152:153], v[184:185], v[12:13], v[152:153] op_sel_hi:[1,0,1]
    v_pk_fma_f32 v[154:155], v[186:187], v[12:13], v[154:155] op_sel_hi:[1,0,1]
    v_pk_fma_f32 v[156:157], v[188:189], v[12:13], v[156:157] op_sel_hi:[1,0,1]
    v_pk_fma_f32 v[158:159], v[190:191], v[12:13], v[158:159] op_sel_hi:[1,0,1]
    v_mul_f32 v16, 0x3fb8aa3b, v14
    v_cvt_pk_bf16_f32 v144, v144, v145
    v_cvt_pk_bf16_f32 v145, v146, v147
    v_cvt_pk_bf16_f32 v146, v148, v149
    v_cvt_pk_bf16_f32 v147, v150, v151
    v_cvt_pk_bf16_f32 v148, v152, v153
    v_cvt_pk_bf16_f32 v149, v154, v155
    v_cvt_pk_bf16_f32 v150, v156, v157
    v_cvt_pk_bf16_f32 v151, v158, v159
    s_waitcnt lgkmcnt(0)
    v_mul_f32 v18, v12, v14
    v_mfma_f32_32x32x16_bf16 v[176:191], a[32:35], v[144:147], 0
    v_mul_f32 v192, v18, v192
    v_mul_f32 v193, v18, v193
    v_mul_f32 v194, v18, v194
    v_mul_f32 v195, v18, v195
    v_mul_f32 v196, v18, v196
    v_mul_f32 v197, v18, v197
    v_mfma_f32_32x32x16_bf16 v[176:191], a[36:39], v[148:151], v[176:191]
    v_mul_f32 v198, v18, v198
    v_mul_f32 v199, v18, v199
    v_mul_f32 v200, v18, v200
    v_mul_f32 v201, v18, v201
    v_mul_f32 v202, v18, v202
    v_mul_f32 v203, v18, v203
    v_mul_f32 v204, v18, v204
    v_mul_f32 v205, v18, v205
    v_mul_f32 v206, v18, v206
    v_mul_f32 v207, v18, v207
    v_pk_fma_f32 v[160:161], v[160:161], v[14:15], v[192:193] op_sel_hi:[1,0,1]
    v_pk_fma_f32 v[162:163], v[162:163], v[14:15], v[194:195] op_sel_hi:[1,0,1]
    v_pk_fma_f32 v[164:165], v[164:165], v[14:15], v[196:197] op_sel_hi:[1,0,1]
    v_pk_fma_f32 v[166:167], v[166:167], v[14:15], v[198:199] op_sel_hi:[1,0,1]
    v_pk_fma_f32 v[168:169], v[168:169], v[14:15], v[200:201] op_sel_hi:[1,0,1]
    v_pk_fma_f32 v[170:171], v[170:171], v[14:15], v[202:203] op_sel_hi:[1,0,1]
    v_pk_fma_f32 v[172:173], v[172:173], v[14:15], v[204:205] op_sel_hi:[1,0,1]
    v_pk_fma_f32 v[174:175], v[174:175], v[14:15], v[206:207] op_sel_hi:[1,0,1]
    v_cndmask_b32_e64 v172, v172, 1.0, s[66:67]
    v_cvt_pk_bf16_f32 v160, v160, v161
    v_cvt_pk_bf16_f32 v161, v162, v163
    v_cvt_pk_bf16_f32 v162, v164, v165
    v_cvt_pk_bf16_f32 v163, v166, v167
    v_cvt_pk_bf16_f32 v164, v168, v169
    v_cvt_pk_bf16_f32 v165, v170, v171
    v_cvt_pk_bf16_f32 v166, v172, v173
    v_cvt_pk_bf16_f32 v167, v174, v175
    ds_write_b128 v8, v[160:163] offset:128
    ds_write_b128 v8, v[164:167] offset:144
    v_max3_f32 v18, v176, v177, v178
    v_max3_f32 v19, -v176, -v177, -v178
    v_max3_f32 v18, v18, v179, v180
    v_max3_f32 v19, v19, -v179, -v180
    v_max3_f32 v18, v18, v181, v182
    v_max3_f32 v19, v19, -v181, -v182
    v_max3_f32 v18, v18, v184, v185
    v_max3_f32 v19, v19, -v184, -v185
    v_max3_f32 v18, v18, v186, v187
    v_max3_f32 v19, v19, -v186, -v187
    v_max3_f32 v18, v18, v188, v189
    v_max3_f32 v19, v19, -v188, -v189
    v_max_f32 v18, v18, v190
    v_max_f32_e64 v19, v19, -v190
    s_nop 1
    v_permlane32_swap_b32 v18, v19
    v_max_f32 v18, v18, v19
    v_mul_f32_e64 v20, -v18, v16
    v_mul_f32_e64 v22, -v18, v16
    s_nop 1
    v_permlane32_swap_b32 v20, v22
    v_pk_fma_f32 v[192:193], v[176:177], v[16:17], v[20:21] op_sel_hi:[1,0,0]
    v_pk_fma_f32 v[194:195], v[178:179], v[16:17], v[20:21] op_sel_hi:[1,0,0]
    v_pk_fma_f32 v[196:197], v[180:181], v[16:17], v[20:21] op_sel_hi:[1,0,0]
    v_pk_fma_f32 v[200:201], v[184:185], v[16:17], v[20:21] op_sel_hi:[1,0,0]
    v_pk_fma_f32 v[202:203], v[186:187], v[16:17], v[20:21] op_sel_hi:[1,0,0]
    v_pk_fma_f32 v[204:205], v[188:189], v[16:17], v[20:21] op_sel_hi:[1,0,0]
    v_fma_f32 v198, v182, v16, v20
    v_fma_f32 v206, v190, v16, v20
    v_exp_f32 v192, v192
    v_exp_f32 v193, v193
    v_exp_f32 v194, v194
    v_exp_f32 v195, v195
    v_exp_f32 v196, v196
    v_exp_f32 v197, v197
    v_exp_f32 v198, v198
    v_exp_f32 v200, v200
    v_exp_f32 v201, v201
    v_exp_f32 v202, v202
    v_exp_f32 v203, v203
    v_exp_f32 v204, v204
    v_exp_f32 v205, v205
    v_exp_f32 v206, v206
    v_pk_fma_f32 v[176:177], v[176:177], v[16:17], v[22:23] op_sel_hi:[1,0,0] neg_lo:[1,0,0] neg_hi:[1,0,0]
    v_pk_fma_f32 v[178:179], v[178:179], v[16:17], v[22:23] op_sel_hi:[1,0,0] neg_lo:[1,0,0] neg_hi:[1,0,0]
    v_pk_fma_f32 v[180:181], v[180:181], v[16:17], v[22:23] op_sel_hi:[1,0,0] neg_lo:[1,0,0] neg_hi:[1,0,0]
    v_pk_fma_f32 v[184:185], v[184:185], v[16:17], v[22:23] op_sel_hi:[1,0,0] neg_lo:[1,0,0] neg_hi:[1,0,0]
    v_pk_fma_f32 v[186:187], v[186:187], v[16:17], v[22:23] op_sel_hi:[1,0,0] neg_lo:[1,0,0] neg_hi:[1,0,0]
    v_pk_fma_f32 v[188:189], v[188:189], v[16:17], v[22:23] op_sel_hi:[1,0,0] neg_lo:[1,0,0] neg_hi:[1,0,0]
    v_fma_f32 v182, -v182, v16, v22
    v_fma_f32 v190, -v190, v16, v22
    v_exp_f32 v176, v176
    v_exp_f32 v177, v177
    v_exp_f32 v178, v178
    v_exp_f32 v179, v179
    v_exp_f32 v180, v180
    v_exp_f32 v181, v181
    v_exp_f32 v182, v182
    v_exp_f32 v184, v184
    v_exp_f32 v185, v185
    v_exp_f32 v186, v186
    v_exp_f32 v187, v187
    v_exp_f32 v188, v188
    v_exp_f32 v189, v189
    v_exp_f32 v190, v190
    v_pk_add_f32 v[20:21], v[192:193], v[194:195]
    v_pk_add_f32 v[22:23], v[176:177], v[178:179]
    v_pk_add_f32 v[20:21], v[20:21], v[196:197]
    v_pk_add_f32 v[22:23], v[22:23], v[180:181]
    v_pk_add_f32 v[20:21], v[20:21], v[200:201]
    v_pk_add_f32 v[22:23], v[22:23], v[184:185]
    v_pk_add_f32 v[20:21], v[20:21], v[202:203]
    v_pk_add_f32 v[22:23], v[22:23], v[186:187]
    v_pk_add_f32 v[20:21], v[20:21], v[204:205]
    v_pk_add_f32 v[22:23], v[22:23], v[188:189]
    v_add_f32 v20, v20, v198
    v_add_f32 v21, v21, v206
    v_add_f32 v22, v22, v182
    v_add_f32 v23, v23, v190
    v_add_f32 v20, v20, v21
    v_add_f32 v22, v22, v23
    s_nop 1
    v_permlane32_swap_b32 v20, v22
    v_add_f32 v18, v20, v22
    v_rcp_f32 v20, v18
    v_rcp_f32 v22, v18
    s_nop 1
    v_permlane32_swap_b32 v20, v22
    v_pk_mul_f32 v[192:193], v[192:193], v[20:21] op_sel_hi:[1,0]
    v_pk_mul_f32 v[194:195], v[194:195], v[20:21] op_sel_hi:[1,0]
    v_pk_mul_f32 v[196:197], v[196:197], v[20:21] op_sel_hi:[1,0]
    v_pk_mul_f32 v[200:201], v[200:201], v[20:21] op_sel_hi:[1,0]
    v_pk_mul_f32 v[202:203], v[202:203], v[20:21] op_sel_hi:[1,0]
    v_pk_mul_f32 v[204:205], v[204:205], v[20:21] op_sel_hi:[1,0]
    v_mul_f32 v198, v198, v20
    v_mul_f32 v206, v206, v20
    v_cvt_pk_bf16_f32 v144, v192, v193
    v_cvt_pk_bf16_f32 v145, v194, v195
    v_cvt_pk_bf16_f32 v146, v196, v197
    v_cvt_pk_bf16_f32 v147, v198, 0
    v_cvt_pk_bf16_f32 v148, v200, v201
    v_cvt_pk_bf16_f32 v149, v202, v203
    v_cvt_pk_bf16_f32 v150, v204, v205
    v_cvt_pk_bf16_f32 v151, v206, 0
    ds_write_b128 v8, v[144:147]
    ds_write_b128 v8, v[148:151] offset:16
    v_pk_mul_f32 v[176:177], v[176:177], v[22:23] op_sel_hi:[1,0]
    v_pk_mul_f32 v[178:179], v[178:179], v[22:23] op_sel_hi:[1,0]
    v_pk_mul_f32 v[180:181], v[180:181], v[22:23] op_sel_hi:[1,0]
    v_pk_mul_f32 v[184:185], v[184:185], v[22:23] op_sel_hi:[1,0]
    v_pk_mul_f32 v[186:187], v[186:187], v[22:23] op_sel_hi:[1,0]
    v_pk_mul_f32 v[188:189], v[188:189], v[22:23] op_sel_hi:[1,0]
    v_mul_f32 v182, v182, v22
    v_mul_f32 v190, v190, v22
    v_cvt_pk_bf16_f32 v152, v176, v177
    v_cvt_pk_bf16_f32 v153, v178, v179
    v_cvt_pk_bf16_f32 v154, v180, v181
    v_cvt_pk_bf16_f32 v155, v182, 0
    v_cvt_pk_bf16_f32 v156, v184, v185
    v_cvt_pk_bf16_f32 v157, v186, v187
    v_cvt_pk_bf16_f32 v158, v188, v189
    v_cvt_pk_bf16_f32 v159, v190, 0
    ds_write_b128 v8, v[152:155] offset:64
    ds_write_b128 v8, v[156:159] offset:80
    v_add_u32 v4, 60672, v4
    v_add_u32 v5, 60672, v5
    v_add_u32 v6, 60672, v6
    v_add_u32 v7, 60672, v7
    s_waitcnt lgkmcnt(0)
    s_barrier
    s_lshl_b32 s3, s48, 11
    s_add_u32 s3, s3, 4096
    v_and_b32 v30, 15, v0
    v_lshlrev_b32 v30, 7, v30
    buffer_load_dwordx2 v[28:29], v30, s[4:7], s3 offen sc1
    s_setprio 0
    s_barrier
    ds_read_b64_tr_b16 a[0:1], v4 offset:0
    ds_read_b64_tr_b16 a[2:3], v4 offset:256
    ds_read_b64_tr_b16 a[4:5], v5 offset:0
    ds_read_b64_tr_b16 a[6:7], v5 offset:256
    ds_read_b64_tr_b16 a[8:9], v6 offset:0
    ds_read_b64_tr_b16 a[10:11], v6 offset:256
    ds_read_b64_tr_b16 a[12:13], v7 offset:0
    ds_read_b64_tr_b16 a[14:15], v7 offset:256
    s_waitcnt lgkmcnt(6)
    v_mfma_f32_32x32x16_bf16 v[144:159], a[0:3], v[32:35], 0
    ds_read_b64_tr_b16 a[16:17], v4 offset:4096
    ds_read_b64_tr_b16 a[18:19], v4 offset:4352
    s_waitcnt lgkmcnt(6)
    v_mfma_f32_32x32x16_bf16 v[144:159], a[4:7], v[36:39], v[144:159]
    ds_read_b64_tr_b16 a[0:1], v5 offset:4096
    ds_read_b64_tr_b16 a[2:3], v5 offset:4352
    s_waitcnt lgkmcnt(6)
    v_mfma_f32_32x32x16_bf16 v[144:159], a[8:11], v[40:43], v[144:159]
    ds_read_b64_tr_b16 a[4:5], v6 offset:4096
    ds_read_b64_tr_b16 a[6:7], v6 offset:4352
    s_waitcnt lgkmcnt(6)
    v_mfma_f32_32x32x16_bf16 v[144:159], a[12:15], v[44:47], v[144:159]
    ds_read_b64_tr_b16 a[8:9], v7 offset:4096
    ds_read_b64_tr_b16 a[10:11], v7 offset:4352
    s_waitcnt lgkmcnt(6)
    v_mfma_f32_32x32x16_bf16 v[144:159], a[16:19], v[48:51], v[144:159]
    ds_read_b64_tr_b16 a[12:13], v4 offset:8192
    ds_read_b64_tr_b16 a[14:15], v4 offset:8448
    s_waitcnt lgkmcnt(6)
    v_mfma_f32_32x32x16_bf16 v[144:159], a[0:3], v[52:55], v[144:159]
    ds_read_b64_tr_b16 a[16:17], v5 offset:8192
    ds_read_b64_tr_b16 a[18:19], v5 offset:8448
    s_waitcnt lgkmcnt(6)
    v_mfma_f32_32x32x16_bf16 v[144:159], a[4:7], v[56:59], v[144:159]
    ds_read_b64_tr_b16 a[0:1], v6 offset:8192
    ds_read_b64_tr_b16 a[2:3], v6 offset:8448
    s_waitcnt lgkmcnt(6)
    v_mfma_f32_32x32x16_bf16 v[144:159], a[8:11], v[60:63], v[144:159]
    ds_read_b64_tr_b16 a[4:5], v7 offset:8192
    ds_read_b64_tr_b16 a[6:7], v7 offset:8448
    s_waitcnt lgkmcnt(6)
    v_mfma_f32_32x32x16_bf16 v[144:159], a[12:15], v[64:67], v[144:159]
    ds_read_b64_tr_b16 a[8:9], v4 offset:12288
    ds_read_b64_tr_b16 a[10:11], v4 offset:12544
    s_waitcnt lgkmcnt(6)
    v_mfma_f32_32x32x16_bf16 v[144:159], a[16:19], v[68:71], v[144:159]
    ds_read_b64_tr_b16 a[12:13], v5 offset:12288
    ds_read_b64_tr_b16 a[14:15], v5 offset:12544
    s_waitcnt lgkmcnt(6)
    v_mfma_f32_32x32x16_bf16 v[144:159], a[0:3], v[72:75], v[144:159]
    ds_read_b64_tr_b16 a[16:17], v6 offset:12288
    ds_read_b64_tr_b16 a[18:19], v6 offset:12544
    s_waitcnt lgkmcnt(6)
    v_mfma_f32_32x32x16_bf16 v[144:159], a[4:7], v[76:79], v[144:159]
    ds_read_b64_tr_b16 a[0:1], v7 offset:12288
    ds_read_b64_tr_b16 a[2:3], v7 offset:12544
    s_waitcnt lgkmcnt(6)
    v_mfma_f32_32x32x16_bf16 v[144:159], a[8:11], v[80:83], v[144:159]
    ds_read_b64_tr_b16 a[4:5], v4 offset:16384
    ds_read_b64_tr_b16 a[6:7], v4 offset:16640
    s_waitcnt lgkmcnt(6)
    v_mfma_f32_32x32x16_bf16 v[144:159], a[12:15], v[84:87], v[144:159]
    ds_read_b64_tr_b16 a[8:9], v5 offset:16384
    ds_read_b64_tr_b16 a[10:11], v5 offset:16640
    s_waitcnt lgkmcnt(6)
    v_mfma_f32_32x32x16_bf16 v[144:159], a[16:19], v[88:91], v[144:159]
    ds_read_b64_tr_b16 a[12:13], v6 offset:16384
    ds_read_b64_tr_b16 a[14:15], v6 offset:16640
    s_waitcnt lgkmcnt(6)
    v_mfma_f32_32x32x16_bf16 v[144:159], a[0:3], v[92:95], v[144:159]
    ds_read_b64_tr_b16 a[16:17], v7 offset:16384
    ds_read_b64_tr_b16 a[18:19], v7 offset:16640
    s_waitcnt lgkmcnt(6)
    v_mfma_f32_32x32x16_bf16 v[144:159], a[4:7], v[96:99], v[144:159]
    ds_read_b64_tr_b16 a[0:1], v4 offset:20480
    ds_read_b64_tr_b16 a[2:3], v4 offset:20736
    s_waitcnt lgkmcnt(6)
    v_mfma_f32_32x32x16_bf16 v[144:159], a[8:11], v[100:103], v[144:159]
    ds_read_b64_tr_b16 a[4:5], v5 offset:20480
    ds_read_b64_tr_b16 a[6:7], v5 offset:20736
    s_waitcnt lgkmcnt(6)
    v_mfma_f32_32x32x16_bf16 v[144:159], a[12:15], v[104:107], v[144:159]
    ds_read_b64_tr_b16 a[8:9], v6 offset:20480
    ds_read_b64_tr_b16 a[10:11], v6 offset:20736
    s_waitcnt lgkmcnt(6)
    v_mfma_f32_32x32x16_bf16 v[144:159], a[16:19], v[108:111], v[144:159]
    ds_read_b64_tr_b16 a[12:13], v7 offset:20480
    ds_read_b64_tr_b16 a[14:15], v7 offset:20736
    s_waitcnt lgkmcnt(6)
    v_mfma_f32_32x32x16_bf16 v[144:159], a[0:3], v[112:115], v[144:159]
    ds_read_b64_tr_b16 a[16:17], v4 offset:24576
    ds_read_b64_tr_b16 a[18:19], v4 offset:24832
    s_waitcnt lgkmcnt(6)
    v_mfma_f32_32x32x16_bf16 v[144:159], a[4:7], v[116:119], v[144:159]
    ds_read_b64_tr_b16 a[0:1], v5 offset:24576
    ds_read_b64_tr_b16 a[2:3], v5 offset:24832
    s_waitcnt lgkmcnt(6)
    v_mfma_f32_32x32x16_bf16 v[144:159], a[8:11], v[120:123], v[144:159]
    ds_read_b64_tr_b16 a[4:5], v6 offset:24576
    ds_read_b64_tr_b16 a[6:7], v6 offset:24832
    s_waitcnt lgkmcnt(6)
    v_mfma_f32_32x32x16_bf16 v[144:159], a[12:15], v[124:127], v[144:159]
    ds_read_b64_tr_b16 a[8:9], v7 offset:24576
    ds_read_b64_tr_b16 a[10:11], v7 offset:24832
    s_waitcnt lgkmcnt(6)
    v_mfma_f32_32x32x16_bf16 v[144:159], a[16:19], v[128:131], v[144:159]
    s_waitcnt lgkmcnt(4)
    v_mfma_f32_32x32x16_bf16 v[144:159], a[0:3], v[132:135], v[144:159]
    s_waitcnt lgkmcnt(2)
    v_mfma_f32_32x32x16_bf16 v[144:159], a[4:7], v[136:139], v[144:159]
    s_waitcnt lgkmcnt(0)
    v_mfma_f32_32x32x16_bf16 v[144:159], a[8:11], v[140:143], v[144:159]
    v_and_b32 v20, 31, v0
    v_lshlrev_b32 v20, 2, v20
    ds_read_b32 v24, v20 offset:57984
    ds_read_b32 v25, v20 offset:58368
    ds_read_b32 v26, v20 offset:58752
    ds_read_b32 v27, v20 offset:59136
    s_waitcnt lgkmcnt(0)
    v_add_f32 v24, v24, v25
    v_add_f32 v26, v26, v27
    v_add_f32 v24, v24, v26
    ds_write_b32 v20, v24 offset:57600
    s_waitcnt vmcnt(0)
    s_mul_i32 s55, s51, 0x9e3779b1
    v_cmp_ne_u32 vcc, s55, v28
    s_nop 0
    s_cbranch_vccz L_rg_56
L_rt_55:
    s_lshl_b32 s3, s48, 11
    s_add_u32 s3, s3, 4096
    v_and_b32 v30, 15, v0
    v_lshlrev_b32 v30, 7, v30
    buffer_load_dwordx2 v[28:29], v30, s[4:7], s3 offen sc1
    s_waitcnt vmcnt(0)
    v_cmp_ne_u32 vcc, s55, v28
    s_nop 0
    s_cbranch_vccz L_ok_57
    s_cmp_eq_u32 s53, 0
    s_cbranch_scc1 L_ok_57
    s_sub_u32 s53, s53, 1
    s_branch L_rt_55
L_ok_57:
L_rg_56:
    s_getreg_b32 s55, hwreg(HW_REG_XCC_ID, 0, 4)
    v_cmp_ne_u32 vcc, s55, v29
    s_nop 0
    s_mov_b32 s52, vcc_lo
    ds_read_b128 v[160:163], v10 offset:0
    ds_read_b128 v[164:167], v10 offset:32
    ds_read_b128 v[168:171], v10 offset:64
    ds_read_b128 v[172:175], v10 offset:96
    s_cmp_lg_u32 s50, s61
    s_cbranch_scc1 L_nodump_58
    v_add_u32 v20, 126464, v1
    s_and_b32 s3, s49, 3
    s_lshl_b32 s3, s3, 3
    s_lshr_b32 s3, 0x18346249, s3
    s_bitcmp1_b32 s3, 0
    s_cbranch_scc0 L_nd_59
    ds_write_b128 v20, v[32:35] offset:0
    ds_write_b128 v20, v[36:39] offset:1024
    ds_write_b128 v20, v[40:43] offset:2048
    ds_write_b128 v20, v[44:47] offset:3072
L_nd_59:
    s_bitcmp1_b32 s3, 1
    s_cbranch_scc0 L_nd_60
    ds_write_b128 v20, v[48:51] offset:4096
    ds_write_b128 v20, v[52:55] offset:5120
    ds_write_b128 v20, v[56:59] offset:6144
    ds_write_b128 v20, v[60:63] offset:7168
L_nd_60:
    s_bitcmp1_b32 s3, 2
    s_cbranch_scc0 L_nd_61
    ds_write_b128 v20, v[64:67] offset:8192
    ds_write_b128 v20, v[68:71] offset:9216
    ds_write_b128 v20, v[72:75] offset:10240
    ds_write_b128 v20, v[76:79] offset:11264
L_nd_61:
    s_bitcmp1_b32 s3, 3
    s_cbranch_scc0 L_nd_62
    ds_write_b128 v20, v[80:83] offset:12288
    ds_write_b128 v20, v[84:87] offset:13312
    ds_write_b128 v20, v[88:91] offset:14336
    ds_write_b128 v20, v[92:95] offset:15360
L_nd_62:
    s_bitcmp1_b32 s3, 4
    s_cbranch_scc0 L_nd_63
    ds_write_b128 v20, v[96:99] offset:16384
    ds_write_b128 v20, v[100:103] offset:17408
    ds_write_b128 v20, v[104:107] offset:18432
    ds_write_b128 v20, v[108:111] offset:19456
L_nd_63:
    s_bitcmp1_b32 s3, 5
    s_cbranch_scc0 L_nd_64
    ds_write_b128 v20, v[112:115] offset:20480
    ds_write_b128 v20, v[116:119] offset:21504
    ds_write_b128 v20, v[120:123] offset:22528
    ds_write_b128 v20, v[124:127] offset:23552
L_nd_64:
    s_bitcmp1_b32 s3, 6
    s_cbranch_scc0 L_nd_65
    ds_write_b128 v20, v[128:131] offset:24576
    ds_write_b128 v20, v[132:135] offset:25600
    ds_write_b128 v20, v[136:139] offset:26624
    ds_write_b128 v20, v[140:143] offset:27648
L_nd_65:
L_nodump_58:
    s_waitcnt lgkmcnt(0)
    v_pk_fma_f32 v[144:145], v[160:161], v[12:13], v[144:145] op_sel_hi:[1,0,1]
    v_pk_fma_f32 v[146:147], v[162:163], v[12:13], v[146:147] op_sel_hi:[1,0,1]
    v_pk_fma_f32 v[148:149], v[164:165], v[12:13], v[148:149] op_sel_hi:[1,0,1]
    v_pk_fma_f32 v[150:151], v[166:167], v[12:13], v[150:151] op_sel_hi:[1,0,1]
    v_pk_fma_f32 v[152:153], v[168:169], v[12:13], v[152:153] op_sel_hi:[1,0,1]
    v_pk_fma_f32 v[154:155], v[170:171], v[12:13], v[154:155] op_sel_hi:[1,0,1]
    v_pk_fma_f32 v[156:157], v[172:173], v[12:13], v[156:157] op_sel_hi:[1,0,1]
    v_pk_fma_f32 v[158:159], v[174:175], v[12:13], v[158:159] op_sel_hi:[1,0,1]
    v_cvt_pk_bf16_f32 v144, v144, v145
    v_cvt_pk_bf16_f32 v145, v146, v147
    v_cvt_pk_bf16_f32 v146, v148, v149
    v_cvt_pk_bf16_f32 v147, v150, v151
    v_cvt_pk_bf16_f32 v148, v152, v153
    v_cvt_pk_bf16_f32 v149, v154, v155
    v_cvt_pk_bf16_f32 v150, v156, v157
    v_cvt_pk_bf16_f32 v151, v158, v159
    v_mfma_f32_32x32x16_bf16 v[176:191], a[32:35], v[144:147], 0
    s_nop 0
    v_mfma_f32_32x32x16_bf16 v[176:191], a[36:39], v[148:151], v[176:191]
    s_nop 11
    v_max3_f32 v18, v176, v177, v178
    v_max3_f32 v19, -v176, -v177, -v178
    v_max3_f32 v18, v18, v179, v180
    v_max3_f32 v19, v19, -v179, -v180
    v_max3_f32 v18, v18, v181, v182
    v_max3_f32 v19, v19, -v181, -v182
    v_max3_f32 v18, v18, v184, v185
    v_max3_f32 v19, v19, -v184, -v185
    v_max3_f32 v18, v18, v186, v187
    v_max3_f32 v19, v19, -v186, -v187
    v_max3_f32 v18, v18, v188, v189
    v_max3_f32 v19, v19, -v188, -v189
    v_max_f32 v18, v18, v190
    v_max_f32_e64 v19, v19, -v190
    s_nop 1
    v_permlane32_swap_b32 v18, v19
    v_max_f32 v18, v18, v19
    v_mul_f32_e64 v20, -v18, v16
    v_mul_f32_e64 v22, -v18, v16
    s_nop 1
    v_permlane32_swap_b32 v20, v22
    v_pk_fma_f32 v[192:193], v[176:177], v[16:17], v[20:21] op_sel_hi:[1,0,0]
    v_pk_fma_f32 v[194:195], v[178:179], v[16:17], v[20:21] op_sel_hi:[1,0,0]
    v_pk_fma_f32 v[196:197], v[180:181], v[16:17], v[20:21] op_sel_hi:[1,0,0]
    v_pk_fma_f32 v[200:201], v[184:185], v[16:17], v[20:21] op_sel_hi:[1,0,0]
    v_pk_fma_f32 v[202:203], v[186:187], v[16:17], v[20:21] op_sel_hi:[1,0,0]
    v_pk_fma_f32 v[204:205], v[188:189], v[16:17], v[20:21] op_sel_hi:[1,0,0]
    v_fma_f32 v198, v182, v16, v20
    v_fma_f32 v206, v190, v16, v20
    v_exp_f32 v192, v192
    v_exp_f32 v193, v193
    v_exp_f32 v194, v194
    v_exp_f32 v195, v195
    v_exp_f32 v196, v196
    v_exp_f32 v197, v197
    v_exp_f32 v198, v198
    v_exp_f32 v200, v200
    v_exp_f32 v201, v201
    v_exp_f32 v202, v202
    v_exp_f32 v203, v203
    v_exp_f32 v204, v204
    v_exp_f32 v205, v205
    v_exp_f32 v206, v206
    v_pk_fma_f32 v[176:177], v[176:177], v[16:17], v[22:23] op_sel_hi:[1,0,0] neg_lo:[1,0,0] neg_hi:[1,0,0]
    v_pk_fma_f32 v[178:179], v[178:179], v[16:17], v[22:23] op_sel_hi:[1,0,0] neg_lo:[1,0,0] neg_hi:[1,0,0]
    v_pk_fma_f32 v[180:181], v[180:181], v[16:17], v[22:23] op_sel_hi:[1,0,0] neg_lo:[1,0,0] neg_hi:[1,0,0]
    v_pk_fma_f32 v[184:185], v[184:185], v[16:17], v[22:23] op_sel_hi:[1,0,0] neg_lo:[1,0,0] neg_hi:[1,0,0]
    v_pk_fma_f32 v[186:187], v[186:187], v[16:17], v[22:23] op_sel_hi:[1,0,0] neg_lo:[1,0,0] neg_hi:[1,0,0]
    v_pk_fma_f32 v[188:189], v[188:189], v[16:17], v[22:23] op_sel_hi:[1,0,0] neg_lo:[1,0,0] neg_hi:[1,0,0]
    v_fma_f32 v182, -v182, v16, v22
    v_fma_f32 v190, -v190, v16, v22
    v_exp_f32 v176, v176
    v_exp_f32 v177, v177
    v_exp_f32 v178, v178
    v_exp_f32 v179, v179
    v_exp_f32 v180, v180
    v_exp_f32 v181, v181
    v_exp_f32 v182, v182
    v_exp_f32 v184, v184
    v_exp_f32 v185, v185
    v_exp_f32 v186, v186
    v_exp_f32 v187, v187
    v_exp_f32 v188, v188
    v_exp_f32 v189, v189
    v_exp_f32 v190, v190
    v_pk_add_f32 v[20:21], v[192:193], v[194:195]
    v_pk_add_f32 v[22:23], v[176:177], v[178:179]
    v_pk_add_f32 v[20:21], v[20:21], v[196:197]
    v_pk_add_f32 v[22:23], v[22:23], v[180:181]
    v_pk_add_f32 v[20:21], v[20:21], v[200:201]
    v_pk_add_f32 v[22:23], v[22:23], v[184:185]
    v_pk_add_f32 v[20:21], v[20:21], v[202:203]
    v_pk_add_f32 v[22:23], v[22:23], v[186:187]
    v_pk_add_f32 v[20:21], v[20:21], v[204:205]
    v_pk_add_f32 v[22:23], v[22:23], v[188:189]
    v_add_f32 v20, v20, v198
    v_add_f32 v21, v21, v206
    v_add_f32 v22, v22, v182
    v_add_f32 v23, v23, v190
    v_add_f32 v20, v20, v21
    v_add_f32 v22, v22, v23
    s_nop 1
    v_permlane32_swap_b32 v20, v22
    v_add_f32 v18, v20, v22
    v_rcp_f32 v20, v18
    v_rcp_f32 v22, v18
    s_nop 1
    v_permlane32_swap_b32 v20, v22
    v_pk_mul_f32 v[192:193], v[192:193], v[20:21] op_sel_hi:[1,0]
    v_pk_mul_f32 v[194:195], v[194:195], v[20:21] op_sel_hi:[1,0]
    v_pk_mul_f32 v[196:197], v[196:197], v[20:21] op_sel_hi:[1,0]
    v_pk_mul_f32 v[200:201], v[200:201], v[20:21] op_sel_hi:[1,0]
    v_pk_mul_f32 v[202:203], v[202:203], v[20:21] op_sel_hi:[1,0]
    v_pk_mul_f32 v[204:205], v[204:205], v[20:21] op_sel_hi:[1,0]
    v_mul_f32 v198, v198, v20
    v_mul_f32 v206, v206, v20
    v_cvt_pk_bf16_f32 v144, v192, v193
    v_cvt_pk_bf16_f32 v145, v194, v195
    v_cvt_pk_bf16_f32 v146, v196, v197
    v_cvt_pk_bf16_f32 v147, v198, 0
    v_cvt_pk_bf16_f32 v148, v200, v201
    v_cvt_pk_bf16_f32 v149, v202, v203
    v_cvt_pk_bf16_f32 v150, v204, v205
    v_cvt_pk_bf16_f32 v151, v206, 0
    v_pk_mul_f32 v[176:177], v[176:177], v[22:23] op_sel_hi:[1,0]
    v_pk_mul_f32 v[178:179], v[178:179], v[22:23] op_sel_hi:[1,0]
    v_pk_mul_f32 v[180:181], v[180:181], v[22:23] op_sel_hi:[1,0]
    v_pk_mul_f32 v[184:185], v[184:185], v[22:23] op_sel_hi:[1,0]
    v_pk_mul_f32 v[186:187], v[186:187], v[22:23] op_sel_hi:[1,0]
    v_pk_mul_f32 v[188:189], v[188:189], v[22:23] op_sel_hi:[1,0]
    v_mul_f32 v182, v182, v22
    v_mul_f32 v190, v190, v22
    v_cvt_pk_bf16_f32 v152, v176, v177
    v_cvt_pk_bf16_f32 v153, v178, v179
    v_cvt_pk_bf16_f32 v154, v180, v181
    v_cvt_pk_bf16_f32 v155, v182, 0
    v_cvt_pk_bf16_f32 v156, v184, v185
    v_cvt_pk_bf16_f32 v157, v186, v187
    v_cvt_pk_bf16_f32 v158, v188, v189
    v_cvt_pk_bf16_f32 v159, v190, 0
    s_lshl_b32 s57, s50, 13
    s_add_u32 s55, s57, s17
    s_add_u32 s56, s55, 4096
    s_add_u32 s57, s57, 93696
    v_add_u32 v15, s57, v1
    v_and_b32 v14, 7, v0
    v_lshlrev_b32 v14, 10, v14
    s_and_b32 s62, s49, 1
    s_sub_u32 s71, 14, s62
    s_mul_i32 s62, s62, 14
    s_mul_i32 s3, s50, 5
    s_add_u32 s62, s62, s3
    s_lshl_b32 s62, s62, 10
    s_add_u32 s62, s62, s17
    s_add_u32 s62, s62, 32768
    s_sub_u32 s71, s71, s3
    s_lshl_b32 s3, s3, 10
    s_add_u32 s3, s3, 126464
    v_add_u32 v17, s3, v1
    s_min_u32 s45, s71, 4
    s_lshl_b32 s45, s45, 10
    s_add_u32 s45, s45, s62
    s_add_u32 s46, s17, 61440
    s_cmp_lg_u32 s50, 3
    s_cbranch_scc1 L_nof_66
    v_bfe_u32 v18, v0, 1, 4
    v_and_b32 v21, 31, v0
    v_cmp_eq_u32 vcc, 1, v21
    s_nop 1
    v_cndmask_b32_e64 v18, v18, 16, vcc
    v_and_b32 v19, 1, v0
    v_lshlrev_b32 v19, 3, v19
    v_cndmask_b32_e64 v19, v19, 0, vcc
    v_lshrrev_b32 v20, 5, v0
    v_lshlrev_b32 v20, 2, v20
    v_mad_u32_u24 v19, v20, v18, v19
    v_cvt_f32_u32 v18, v18
    v_cvt_f32_u32 v19, v19
    v_mul_f32 v18, 0x3d000000, v18
    v_mul_f32 v19, 0x3d000000, v19
    v_lshlrev_b32 v21, 2, v21
    v_lshlrev_b32 v20, 2, v20
    v_add_u32 v22, 151040, v1
    v_fmamk_f32 v160, v18, 0x0, v19
    v_fmamk_f32 v161, v18, 0x3f800000, v19
    v_fmamk_f32 v162, v18, 0x40000000, v19
    v_fmamk_f32 v163, v18, 0x40400000, v19
    v_fmamk_f32 v164, v18, 0x41000000, v19
    v_fmamk_f32 v165, v18, 0x41100000, v19
    v_fmamk_f32 v166, v18, 0x41200000, v19
    v_fmamk_f32 v167, v18, 0x41300000, v19
    v_fmamk_f32 v168, v18, 0x41800000, v19
    v_fmamk_f32 v169, v18, 0x41880000, v19
    v_fmamk_f32 v170, v18, 0x41900000, v19
    v_fmamk_f32 v171, v18, 0x41980000, v19
    v_fmamk_f32 v172, v18, 0x41c00000, v19
    v_fmamk_f32 v173, v18, 0x41c80000, v19
    v_fmamk_f32 v174, v18, 0x41d00000, v19
    v_fmamk_f32 v175, v18, 0x41d80000, v19
    v_cos_f32 v160, v160
    v_cos_f32 v161, v161
    v_cos_f32 v162, v162
    v_cos_f32 v163, v163
    v_cos_f32 v164, v164
    v_cos_f32 v165, v165
    v_cos_f32 v166, v166
    v_cos_f32 v167, v167
    v_cos_f32 v168, v168
    v_cos_f32 v169, v169
    v_cos_f32 v170, v170
    v_cos_f32 v171, v171
    v_cos_f32 v172, v172
    v_cos_f32 v173, v173
    v_cos_f32 v174, v174
    v_cos_f32 v175, v175
L_nof_66:
    s_setprio 2
    s_barrier
    ds_read_b128 v[32:35], v9 offset:0
    ds_read_b128 v[36:39], v9 offset:512
    ds_read_b128 v[40:43], v9 offset:1024
    ds_read_b128 v[44:47], v9 offset:1536
    s_waitcnt lgkmcnt(3)
    v_mfma_f32_32x32x16_bf16 v[176:191], v[32:35], v[144:147], 0
    s_waitcnt lgkmcnt(2)
    v_mfma_f32_32x32x16_bf16 v[176:191], v[36:39], v[148:151], v[176:191]
    s_waitcnt lgkmcnt(1)
    v_mfma_f32_32x32x16_bf16 v[176:191], v[40:43], v[152:155], v[176:191]
    s_waitcnt lgkmcnt(0)
    v_mfma_f32_32x32x16_bf16 v[176:191], v[44:47], v[156:159], v[176:191]
    s_nop 11
    v_add_f32 v12, 0x358637bd, v183
    v_rcp_f32 v12, v12
    s_nop 0
    v_pk_mul_f32 v[176:177], v[176:177], v[12:13] op_sel_hi:[1,0]
    v_pk_mul_f32 v[178:179], v[178:179], v[12:13] op_sel_hi:[1,0]
    v_pk_mul_f32 v[180:181], v[180:181], v[12:13] op_sel_hi:[1,0]
    v_pk_mul_f32 v[182:183], v[182:183], v[12:13] op_sel_hi:[1,0]
    v_pk_mul_f32 v[184:185], v[184:185], v[12:13] op_sel_hi:[1,0]
    v_pk_mul_f32 v[186:187], v[186:187], v[12:13] op_sel_hi:[1,0]
    v_pk_mul_f32 v[188:189], v[188:189], v[12:13] op_sel_hi:[1,0]
    v_pk_mul_f32 v[190:191], v[190:191], v[12:13] op_sel_hi:[1,0]
    v_cvt_pk_bf16_f32 v192, v176, v177
    v_cvt_pk_bf16_f32 v193, v178, v179
    v_cvt_pk_bf16_f32 v194, v180, v181
    v_cvt_pk_bf16_f32 v195, v182, v2
    v_cvt_pk_bf16_f32 v196, v184, v185
    v_cvt_pk_bf16_f32 v197, v186, v187
    v_cvt_pk_bf16_f32 v198, v188, v189
    v_cvt_pk_bf16_f32 v199, v190, v2
    s_cmp_eq_u32 s52, 0
    s_cbranch_scc0 L_slow_67
    buffer_store_dwordx4 v[192:195], v1, s[4:7], s37 offen offset:0
    buffer_store_dwordx4 v[196:199], v1, s[4:7], s37 offen offset:1024
    s_branch L_done_68
L_slow_67:
    buffer_store_dwordx4 v[192:195], v1, s[4:7], s37 offen offset:0 sc1
    buffer_store_dwordx4 v[196:199], v1, s[4:7], s37 offen offset:1024 sc1
L_done_68:
    s_sleep 6
L_o_69:
    s_mov_b32 m0, s57
    buffer_load_dword v16, v14, s[4:7], s55 offen offset:1020 sc1
    buffer_load_dwordx4 v[32:35], v1, s[4:7], s55 offen offset:0 sc1
    buffer_load_dwordx4 v[36:39], v1, s[4:7], s55 offen offset:1024 sc1
    s_waitcnt vmcnt(2)
    v_xor_b32 v16, s70, v16
    v_cmp_lt_u32 vcc, 0xffff, v16
    s_nop 0
    s_cbranch_vccz L_ok_70
    s_cmp_eq_u32 s53, 0
    s_cbranch_scc1 L_ok_70
    s_sub_u32 s53, s53, 1
    s_branch L_o_69
L_ok_70:
    buffer_load_dwordx4 v1, s[4:7], s55 offen offset:2048 sc1 lds
    buffer_load_dwordx4 v1, s[4:7], s55 offen offset:3072 sc1 lds
    s_waitcnt vmcnt(2)
    ds_write_b128 v15, v[32:35] offset:0
    ds_write_b128 v15, v[36:39] offset:1024
    s_add_u32 m0, s57, 4096
    s_nop 0
    buffer_load_dwordx4 v1, s[4:7], s56 offen offset:0 sc1 lds
    buffer_load_dwordx4 v1, s[4:7], s56 offen offset:1024 sc1 lds
    buffer_load_dwordx4 v1, s[4:7], s56 offen offset:2048 sc1 lds
    buffer_load_dwordx4 v1, s[4:7], s56 offen offset:3072 sc1 lds
    v_xor_b32 v16, v35, v2
    v_bitop3_b32 v16, v16, v39, v2 bitop3:0xf6
    v_cmp_lt_u32 vcc, 0xffff, v16
    s_nop 0
    s_cbranch_vccz L_rg_72
L_rt_71:
    buffer_load_dwordx4 v[32:35], v1, s[4:7], s55 offen offset:0 sc1
    buffer_load_dwordx4 v[36:39], v1, s[4:7], s55 offen offset:1024 sc1
    s_waitcnt vmcnt(0)
    ds_write_b128 v15, v[32:35] offset:0
    ds_write_b128 v15, v[36:39] offset:1024
    s_waitcnt vmcnt(0)
    v_xor_b32 v16, v35, v2
    v_bitop3_b32 v16, v16, v39, v2 bitop3:0xf6
    v_cmp_lt_u32 vcc, 0xffff, v16
    s_nop 0
    s_cbranch_vccz L_ok_73
    s_cmp_eq_u32 s53, 0
    s_cbranch_scc1 L_ok_73
    s_sub_u32 s53, s53, 1
    s_branch L_rt_71
L_ok_73:
L_rg_72:
    s_waitcnt lgkmcnt(0)
    s_waitcnt vmcnt(6)
    s_barrier
    s_waitcnt vmcnt(4)
    s_barrier
    s_add_u32 s3, s22, 32768
    v_lshlrev_b32 v23, 7, v0
    s_mov_b64 exec, 0xffff
    buffer_load_dword v24, v23, s[4:7], s3 offen sc1
    s_mov_b64 exec, -1
    s_waitcnt vmcnt(3)
    s_barrier
    s_waitcnt vmcnt(1)
    s_barrier
    s_setprio 0
    v_and_b32 v88, 15, v0
    s_and_b32 s3, s50, 1
    s_lshl_b32 s3, s3, 4
    v_add_u32 v88, s3, v88
    v_sub_u32 v89, 31, v88
    v_and_b32 v90, 16, v0
    v_lshlrev_b32 v90, 5, v90
    v_lshrrev_b32 v91, 5, v0
    v_lshl_add_u32 v90, v91, 3, v90
    v_lshl_add_u32 v99, v88, 4, v90
    v_lshl_add_u32 v100, v89, 4, v90
    v_add_u32 v100, 196608, v100
    s_cmp_eq_u32 s49, 0
    s_cselect_b32 vcc_lo, 0xffff, 0
    s_mov_b32 vcc_hi, 0
    v_cndmask_b32_e64 v102, 1.0, 0, vcc
    v_and_b32 v101, 48, v0
    v_add_lshl_u32 v101, v101, v0, 3
    v_add_u32 v101, 142848, v101
    s_and_b32 s24, s50, 2
    s_lshl_b32 s24, s24, 4
    s_add_u32 s24, s24, s48
    s_sub_u32 s25, 64, s24
    s_add_u32 s3, s24, 16
    s_cmp_eq_u32 s48, 0
    s_cselect_b32 s25, s3, s25
    v_add_u32 v98, 12288, v89
    s_mov_b32 vcc_lo, 0x0000ffff
    s_mov_b32 vcc_hi, 0x0000ffff
    v_cndmask_b32 v98, v98, v88, vcc
    v_and_b32 v93, 32, v0
    v_add_lshl_u32 v98, v98, v93, 4
    v_and_b32 v92, 48, v0
    v_lshlrev_b32 v92, 1, v92
    v_add_lshl_u32 v96, v88, v92, 4
    v_add_lshl_u32 v97, v89, v92, 4
    v_add_u32 v97, 196608, v97
    s_lshl_b32 s30, s49, 11
    s_add_u32 s30, s30, s18
    s_add_u32 s30, s30, 65536
    s_lshr_b32 s3, s49, 2
    s_lshl_b32 s3, s3, 10
    s_add_u32 s31, s18, s3
    s_and_b32 s3, s49, 3
    s_lshl_b32 s3, s3, 2
    s_add_u32 s31, s31, s3
    s_add_u32 s31, s31, 94208
    v_lshl_add_u32 v192, v88, 6, s24
    v_cvt_f32_u32 v192, v192
    v_mul_f32 v192, 0x3a000000, v192
    v_and_b32 v193, 48, v0
    v_cvt_f32_u32 v193, v193
    v_mul_f32 v193, 0.5, v193
    v_mul_f32 v193, v193, v192
    v_fmamk_f32 v176, v192, 0x0, v193
    v_fmamk_f32 v177, v192, 0x3f800000, v193
    v_fmamk_f32 v178, v192, 0x40000000, v193
    v_fmamk_f32 v179, v192, 0x40400000, v193
    v_fmamk_f32 v180, v192, 0x40800000, v193
    v_fmamk_f32 v181, v192, 0x40a00000, v193
    v_fmamk_f32 v182, v192, 0x40c00000, v193
    v_fmamk_f32 v183, v192, 0x40e00000, v193
    v_sin_f32_e64 v184, -v176
    v_cos_f32 v176, v176
    v_sin_f32_e64 v185, -v177
    v_cos_f32 v177, v177
    v_sin_f32_e64 v186, -v178
    v_cos_f32 v178, v178
    v_sin_f32_e64 v187, -v179
    v_cos_f32 v179, v179
    v_sin_f32_e64 v188, -v180
    v_cos_f32 v180, v180
    v_sin_f32_e64 v189, -v181
    v_cos_f32 v181, v181
    v_sin_f32_e64 v190, -v182
    v_cos_f32 v182, v182
    v_sin_f32_e64 v191, -v183
    v_cos_f32 v183, v183
    v_cvt_pk_bf16_f32 v120, v184, v185
    v_cvt_pk_bf16_f32 v112, v176, v177
    v_cvt_pk_bf16_f32 v121, v186, v187
    v_cvt_pk_bf16_f32 v113, v178, v179
    v_cvt_pk_bf16_f32 v122, v188, v189
    v_cvt_pk_bf16_f32 v114, v180, v181
    v_cvt_pk_bf16_f32 v123, v190, v191
    v_cvt_pk_bf16_f32 v115, v182, v183
    v_fmamk_f32 v176, v192, 0x42000000, v193
    v_fmamk_f32 v177, v192, 0x42040000, v193
    v_fmamk_f32 v178, v192, 0x42080000, v193
    v_fmamk_f32 v179, v192, 0x420c0000, v193
    v_fmamk_f32 v180, v192, 0x42100000, v193
    v_fmamk_f32 v181, v192, 0x42140000, v193
    v_fmamk_f32 v182, v192, 0x42180000, v193
    v_fmamk_f32 v183, v192, 0x421c0000, v193
    v_sin_f32_e64 v184, -v176
    v_cos_f32 v176, v176
    v_sin_f32_e64 v185, -v177
    v_cos_f32 v177, v177
    v_sin_f32_e64 v186, -v178
    v_cos_f32 v178, v178
    v_sin_f32_e64 v187, -v179
    v_cos_f32 v179, v179
    v_sin_f32_e64 v188, -v180
    v_cos_f32 v180, v180
    v_sin_f32_e64 v189, -v181
    v_cos_f32 v181, v181
    v_sin_f32_e64 v190, -v182
    v_cos_f32 v182, v182
    v_sin_f32_e64 v191, -v183
    v_cos_f32 v183, v183
    v_cvt_pk_bf16_f32 v124, v184, v185
    v_cvt_pk_bf16_f32 v116, v176, v177
    v_cvt_pk_bf16_f32 v125, v186, v187
    v_cvt_pk_bf16_f32 v117, v178, v179
    v_cvt_pk_bf16_f32 v126, v188, v189
    v_cvt_pk_bf16_f32 v118, v180, v181
    v_cvt_pk_bf16_f32 v127, v190, v191
    v_cvt_pk_bf16_f32 v119, v182, v183
    s_setprio 2
    s_barrier
    v_mov_b32 v16, 60160
    ds_read_b32 v16, v16
    s_waitcnt lgkmcnt(0)
    v_cmp_ne_u32 vcc, 0, v16
    s_nop 0
    s_cbranch_vccnz L_o_69
    s_cmp_lg_u32 s50, 3
    s_cbranch_scc1 L_nof_74
    s_sleep 5
    buffer_load_dwordx4 v[48:51], v1, s[4:7], s46 offen offset:0 sc1
    buffer_load_dwordx4 v[52:55], v1, s[4:7], s46 offen offset:1024 sc1
    buffer_load_dwordx4 v[56:59], v1, s[4:7], s46 offen offset:2048 sc1
    buffer_load_dwordx4 v[60:63], v1, s[4:7], s46 offen offset:3072 sc1
    s_waitcnt vmcnt(0)
    v_max3_u32 v16, v48, v49, v50
    v_max3_u32 v16, v16, v51, v52
    v_max3_u32 v16, v16, v53, v54
    v_max3_u32 v16, v16, v55, v56
    v_max3_u32 v16, v16, v57, v58
    v_max3_u32 v16, v16, v59, v60
    v_max_u32 v16, v16, v61
    v_cmp_eq_u32 vcc, -1, v16
    s_nop 0
    s_cbranch_vccnz L_sl_75
    v_add_f32 v48, v48, v49
    v_add_f32 v50, v50, v51
    v_add_f32 v52, v52, v53
    v_add_f32 v54, v54, v55
    v_add_f32 v56, v56, v57
    v_add_f32 v58, v58, v59
    v_add_f32 v60, v60, v61
    v_add_f32 v48, v48, v50
    v_add_f32 v52, v52, v54
    v_add_f32 v56, v56, v58
    v_add_f32 v48, v48, v52
    v_add_f32 v56, v56, v60
    v_add_f32 v48, v48, v56
    v_mul_f32 v48, 0x3b124925, v48
    v_mov_b32 v49, v48
    s_nop 1
    v_permlane32_swap_b32 v48, v49
    v_fma_f32 v49, -v48, v48, v49
    v_max_f32 v49, 0, v49
    v_add_f32 v49, 0x3727c5ac, v49
    v_rsq_f32 v16, v49
    s_barrier
    s_branch L_sj_76
L_sl_75:
    buffer_load_dwordx4 v[48:51], v1, s[4:7], s46 offen offset:0 sc1
    buffer_load_dwordx4 v[52:55], v1, s[4:7], s46 offen offset:1024 sc1
    buffer_load_dwordx4 v[56:59], v1, s[4:7], s46 offen offset:2048 sc1
    buffer_load_dwordx4 v[60:63], v1, s[4:7], s46 offen offset:3072 sc1
    s_barrier
    s_waitcnt vmcnt(0)
    v_max3_u32 v16, v48, v49, v50
    v_max3_u32 v16, v16, v51, v52
    v_max3_u32 v16, v16, v53, v54
    v_max3_u32 v16, v16, v55, v56
    v_max3_u32 v16, v16, v57, v58
    v_max3_u32 v16, v16, v59, v60
    v_max_u32 v16, v16, v61
    v_cmp_eq_u32 vcc, -1, v16
    s_nop 0
    s_cbranch_vccz L_rg_78
L_rt_77:
    buffer_load_dwordx4 v[48:51], v1, s[4:7], s46 offen offset:0 sc1
    buffer_load_dwordx4 v[52:55], v1, s[4:7], s46 offen offset:1024 sc1
    buffer_load_dwordx4 v[56:59], v1, s[4:7], s46 offen offset:2048 sc1
    buffer_load_dwordx4 v[60:63], v1, s[4:7], s46 offen offset:3072 sc1
    s_waitcnt vmcnt(0)
    v_max3_u32 v16, v48, v49, v50
    v_max3_u32 v16, v16, v51, v52
    v_max3_u32 v16, v16, v53, v54
    v_max3_u32 v16, v16, v55, v56
    v_max3_u32 v16, v16, v57, v58
    v_max3_u32 v16, v16, v59, v60
    v_max_u32 v16, v16, v61
    v_cmp_eq_u32 vcc, -1, v16
    s_nop 0
    s_cbranch_vccz L_ok_79
    s_cmp_eq_u32 s53, 0
    s_cbranch_scc1 L_ok_79
    s_sub_u32 s53, s53, 1
    s_branch L_rt_77
L_ok_79:
L_rg_78:
    v_add_f32 v48, v48, v49
    v_add_f32 v50, v50, v51
    v_add_f32 v52, v52, v53
    v_add_f32 v54, v54, v55
    v_add_f32 v56, v56, v57
    v_add_f32 v58, v58, v59
    v_add_f32 v60, v60, v61
    v_add_f32 v48, v48, v50
    v_add_f32 v52, v52, v54
    v_add_f32 v56, v56, v58
    v_add_f32 v48, v48, v52
    v_add_f32 v56, v56, v60
    v_add_f32 v48, v48, v56
    v_mul_f32 v48, 0x3b124925, v48
    v_mov_b32 v49, v48
    s_nop 1
    v_permlane32_swap_b32 v48, v49
    v_fma_f32 v49, -v48, v48, v49
    v_max_f32 v49, 0, v49
    v_add_f32 v49, 0x3727c5ac, v49
    v_rsq_f32 v16, v49
L_sj_76:
    s_nop 0
    ds_write_b32 v21, v16 offset:59520
    ds_read_b128 v[64:67], v20 offset:59520
    ds_read_b128 v[68:71], v20 offset:59552
    ds_read_b128 v[72:75], v20 offset:59584
    ds_read_b128 v[76:79], v20 offset:59616
    s_waitcnt lgkmcnt(3)
    v_mul_f32 v64, v64, v160
    v_mul_f32 v65, v65, v161
    v_mul_f32 v66, v66, v162
    v_mul_f32 v67, v67, v163
    v_cvt_pk_bf16_f32 v80, v64, v65
    v_cvt_pk_bf16_f32 v81, v66, v67
    s_waitcnt lgkmcnt(2)
    v_mul_f32 v68, v68, v164
    v_mul_f32 v69, v69, v165
    v_mul_f32 v70, v70, v166
    v_mul_f32 v71, v71, v167
    v_cvt_pk_bf16_f32 v82, v68, v69
    v_cvt_pk_bf16_f32 v83, v70, v71
    s_waitcnt lgkmcnt(1)
    v_mul_f32 v72, v72, v168
    v_mul_f32 v73, v73, v169
    v_mul_f32 v74, v74, v170
    v_mul_f32 v75, v75, v171
    v_cvt_pk_bf16_f32 v84, v72, v73
    v_cvt_pk_bf16_f32 v85, v74, v75
    s_waitcnt lgkmcnt(0)
    v_mul_f32 v76, v76, v172
    v_mul_f32 v77, v77, v173
    v_mul_f32 v78, v78, v174
    v_mul_f32 v79, v79, v175
    v_cvt_pk_bf16_f32 v86, v76, v77
    v_cvt_pk_bf16_f32 v87, v78, v79
    ds_write_b128 v22, v[80:83]
    ds_write_b128 v22, v[84:87] offset:1024
    s_waitcnt lgkmcnt(0)
    s_branch L_fj_80
L_nof_74:
    s_sleep 3
L_xe_81:
    buffer_load_dwordx4 v[32:35], v1, s[4:7], s62 offen offset:0 sc1
    buffer_load_dwordx4 v[36:39], v1, s[4:7], s62 offen offset:1024 sc1
    buffer_load_dwordx4 v[40:43], v1, s[4:7], s62 offen offset:2048 sc1
    buffer_load_dwordx4 v[44:47], v1, s[4:7], s62 offen offset:3072 sc1
    buffer_load_dwordx4 v[48:51], v1, s[4:7], s45 offen sc1
    s_waitcnt vmcnt(4)
    ds_write_b128 v17, v[32:35] offset:0
    s_waitcnt vmcnt(3)
    ds_write_b128 v17, v[36:39] offset:1024
    s_waitcnt vmcnt(2)
    ds_write_b128 v17, v[40:43] offset:2048
    s_waitcnt vmcnt(1)
    ds_write_b128 v17, v[44:47] offset:3072
    s_waitcnt vmcnt(0)
    ds_write_b128 v17, v[48:51] offset:4096
    v_max3_u32 v16, v32, v36, v40
    v_max3_u32 v16, v16, v44, v48
    v_cmp_eq_u32 vcc, -1, v16
    s_nop 0
    s_cbranch_vccz L_ok_82
    s_cmp_eq_u32 s53, 0
    s_cbranch_scc1 L_ok_82
    s_sub_u32 s53, s53, 1
    s_branch L_xe_81
L_ok_82:
    s_waitcnt lgkmcnt(0)
    s_barrier
L_fj_80:
    s_add_u32 s3, s22, 65536
    v_lshlrev_b32 v23, 7, v0
    s_mov_b64 exec, 0xffff
    buffer_load_dword v24, v23, s[4:7], s3 offen sc1
    s_mov_b64 exec, -1
    s_barrier
    s_setprio 0
    s_lshl_b32 s54, s49, 10
    s_add_u32 s54, s54, s18
    s_add_u32 s44, s54, 32768
    s_add_u32 s45, s54, 47104
    v_lshrrev_b32 v12, 5, v0
    v_bfe_u32 v13, v0, 2, 2
    v_lshl_add_u32 v12, v12, 2, v13
    v_bfe_u32 v13, v0, 4, 1
    v_and_b32 v14, 3, v0
    v_lshl_add_u32 v13, v13, 2, v14
    v_lshlrev_b32 v13, 3, v13
    v_lshl_add_u32 v4, v12, 6, v13
    v_sub_u32 v12, 232, v12
    v_lshl_add_u32 v5, v12, 6, v13
    v_min_u32 v31, 27, v0
    v_lshrrev_b32 v13, 1, v31
    v_and_b32 v31, 1, v31
    v_lshlrev_b32 v31, 8, v31
    v_lshl_add_u32 v31, v13, 11, v31
    s_cmp_lt_u32 s50, 2
    s_cselect_b32 s3, 128, 0
    s_add_u32 s3, s3, 67072
    v_add_u32 v31, s3, v31
    s_add_u32 s51, s51, 1
    v_and_b32 v12, 15, v0
    v_mul_u32_u24 v12, 0x2f35, v12
    v_add_u32 v12, s51, v12
    v_and_b32 v13, 0x1fff, v12
    v_and_b32 v12, 0x2000, v12
    v_lshl_or_b32 v12, v12, 2, v13
    v_or_b32 v12, 0x2000, v12
    v_lshlrev_b32 v2, 16, v12
    s_nop 0
    v_readlane_b32 s70, v2, 15
    s_barrier
    s_cmp_ge_u32 s49, 14
    s_cbranch_scc1 L_g4skip_83
    buffer_load_dwordx2 v[64:65], v99, s[4:7], s44 offen sc1
    buffer_load_dwordx2 v[66:67], v99, s[4:7], s45 offen sc1
    buffer_load_dwordx2 v[68:69], v100, s[4:7], s44 offen sc1
    buffer_load_dwordx2 v[70:71], v100, s[4:7], s45 offen sc1
    s_cmp_lg_u32 s48, 0
    s_cbranch_scc1 L_nz_84
    v_lshl_add_u32 v192, v89, 6, s25
    v_cvt_f32_u32 v192, v192
    v_mul_f32 v192, 0x3a000000, v192
    v_and_b32 v193, 48, v0
    v_cvt_f32_u32 v193, v193
    v_mul_f32 v193, 0.5, v193
    v_mul_f32 v193, v193, v192
    v_fmamk_f32 v176, v192, 0x0, v193
    v_fmamk_f32 v177, v192, 0x3f800000, v193
    v_fmamk_f32 v178, v192, 0x40000000, v193
    v_fmamk_f32 v179, v192, 0x40400000, v193
    v_fmamk_f32 v180, v192, 0x40800000, v193
    v_fmamk_f32 v181, v192, 0x40a00000, v193
    v_fmamk_f32 v182, v192, 0x40c00000, v193
    v_fmamk_f32 v183, v192, 0x40e00000, v193
    v_sin_f32_e64 v184, -v176
    v_cos_f32 v176, v176
    v_sin_f32_e64 v185, -v177
    v_cos_f32 v177, v177
    v_sin_f32_e64 v186, -v178
    v_cos_f32 v178, v178
    v_sin_f32_e64 v187, -v179
    v_cos_f32 v179, v179
    v_sin_f32_e64 v188, -v180
    v_cos_f32 v180, v180
    v_sin_f32_e64 v189, -v181
    v_cos_f32 v181, v181
    v_sin_f32_e64 v190, -v182
    v_cos_f32 v182, v182
    v_sin_f32_e64 v191, -v183
    v_cos_f32 v183, v183
    v_cvt_pk_bf16_f32 v136, v184, v185
    v_cvt_pk_bf16_f32 v128, v176, v177
    v_cvt_pk_bf16_f32 v137, v186, v187
    v_cvt_pk_bf16_f32 v129, v178, v179
    v_cvt_pk_bf16_f32 v138, v188, v189
    v_cvt_pk_bf16_f32 v130, v180, v181
    v_cvt_pk_bf16_f32 v139, v190, v191
    v_cvt_pk_bf16_f32 v131, v182, v183
    v_fmamk_f32 v176, v192, 0x42000000, v193
    v_fmamk_f32 v177, v192, 0x42040000, v193
    v_fmamk_f32 v178, v192, 0x42080000, v193
    v_fmamk_f32 v179, v192, 0x420c0000, v193
    v_fmamk_f32 v180, v192, 0x42100000, v193
    v_fmamk_f32 v181, v192, 0x42140000, v193
    v_fmamk_f32 v182, v192, 0x42180000, v193
    v_fmamk_f32 v183, v192, 0x421c0000, v193
    v_sin_f32_e64 v184, -v176
    v_cos_f32 v176, v176
    v_sin_f32_e64 v185, -v177
    v_cos_f32 v177, v177
    v_sin_f32_e64 v186, -v178
    v_cos_f32 v178, v178
    v_sin_f32_e64 v187, -v179
    v_cos_f32 v179, v179
    v_sin_f32_e64 v188, -v180
    v_cos_f32 v180, v180
    v_sin_f32_e64 v189, -v181
    v_cos_f32 v181, v181
    v_sin_f32_e64 v190, -v182
    v_cos_f32 v182, v182
    v_sin_f32_e64 v191, -v183
    v_cos_f32 v183, v183
    v_cvt_pk_bf16_f32 v140, v184, v185
    v_cvt_pk_bf16_f32 v132, v176, v177
    v_cvt_pk_bf16_f32 v141, v186, v187
    v_cvt_pk_bf16_f32 v133, v178, v179
    v_cvt_pk_bf16_f32 v142, v188, v189
    v_cvt_pk_bf16_f32 v134, v180, v181
    v_cvt_pk_bf16_f32 v143, v190, v191
    v_cvt_pk_bf16_f32 v135, v182, v183
L_nz_84:
    s_waitcnt vmcnt(0)
    v_max3_u32 v18, v64, v66, v68
    v_max_u32 v18, v18, v70
    v_cmp_eq_u32 vcc, -1, v18
    s_nop 0
    s_cbranch_vccz L_rg_86
L_rt_85:
    buffer_load_dwordx2 v[64:65], v99, s[4:7], s44 offen sc1
    buffer_load_dwordx2 v[66:67], v99, s[4:7], s45 offen sc1
    buffer_load_dwordx2 v[68:69], v100, s[4:7], s44 offen sc1
    buffer_load_dwordx2 v[70:71], v100, s[4:7], s45 offen sc1
    s_waitcnt vmcnt(0)
    v_max3_u32 v18, v64, v66, v68
    v_max_u32 v18, v18, v70
    v_cmp_eq_u32 vcc, -1, v18
    s_nop 0
    s_cbranch_vccz L_ok_87
    s_cmp_eq_u32 s53, 0
    s_cbranch_scc1 L_ok_87
    s_sub_u32 s53, s53, 1
    s_branch L_rt_85
L_ok_87:
L_rg_86:
    v_lshlrev_b32 v144, 16, v64
    v_and_b32 v145, 0xffff0000, v64
    v_lshlrev_b32 v146, 16, v65
    v_and_b32 v147, 0xffff0000, v65
    v_lshlrev_b32 v148, 16, v66
    v_and_b32 v149, 0xffff0000, v66
    v_lshlrev_b32 v150, 16, v67
    v_and_b32 v151, 0xffff0000, v67
    v_pk_add_f32 v[72:73], v[144:145], v[148:149]
    v_pk_add_f32 v[76:77], v[144:145], v[148:149] neg_lo:[0,1] neg_hi:[0,1]
    v_pk_add_f32 v[74:75], v[146:147], v[150:151]
    v_pk_add_f32 v[78:79], v[146:147], v[150:151] neg_lo:[0,1] neg_hi:[0,1]
    v_lshlrev_b32 v144, 16, v68
    v_and_b32 v145, 0xffff0000, v68
    v_lshlrev_b32 v146, 16, v69
    v_and_b32 v147, 0xffff0000, v69
    v_lshlrev_b32 v148, 16, v70
    v_and_b32 v149, 0xffff0000, v70
    v_lshlrev_b32 v150, 16, v71
    v_and_b32 v151, 0xffff0000, v71
    v_pk_add_f32 v[80:81], v[144:145], v[148:149]
    v_pk_add_f32 v[84:85], v[144:145], v[148:149] neg_lo:[0,1] neg_hi:[0,1]
    v_pk_add_f32 v[82:83], v[146:147], v[150:151]
    v_pk_add_f32 v[86:87], v[146:147], v[150:151] neg_lo:[0,1] neg_hi:[0,1]
    v_pk_mul_f32 v[72:73], v[72:73], 0.5 op_sel_hi:[1,0]
    v_pk_mul_f32 v[74:75], v[74:75], 0.5 op_sel_hi:[1,0]
    v_pk_mul_f32 v[76:77], v[76:77], 0.5 op_sel_hi:[1,0]
    v_pk_mul_f32 v[78:79], v[78:79], 0.5 op_sel_hi:[1,0]
    v_pk_mul_f32 v[80:81], v[80:81], 0.5 op_sel_hi:[1,0]
    v_pk_mul_f32 v[82:83], v[82:83], 0.5 op_sel_hi:[1,0]
    v_pk_mul_f32 v[84:85], v[84:85], 0.5 op_sel_hi:[1,0]
    v_pk_mul_f32 v[86:87], v[86:87], 0.5 op_sel_hi:[1,0]
    s_setprio 2
    s_barrier
    ds_read_b64_tr_b16 v[32:33], v101 offset:0
    ds_read_b64_tr_b16 v[34:35], v101 offset:128
    ds_read_b64_tr_b16 v[36:37], v101 offset:1024
    ds_read_b64_tr_b16 v[38:39], v101 offset:1152
    ds_read_b64_tr_b16 v[40:41], v101 offset:2048
    ds_read_b64_tr_b16 v[42:43], v101 offset:2176
    ds_read_b64_tr_b16 v[44:45], v101 offset:3072
    ds_read_b64_tr_b16 v[46:47], v101 offset:3200
    ds_read_b64_tr_b16 v[48:49], v101 offset:4096
    ds_read_b64_tr_b16 v[50:51], v101 offset:4224
    ds_read_b64_tr_b16 v[52:53], v101 offset:5120
    ds_read_b64_tr_b16 v[54:55], v101 offset:5248
    ds_read_b64_tr_b16 v[56:57], v101 offset:6144
    ds_read_b64_tr_b16 v[58:59], v101 offset:6272
    ds_read_b64_tr_b16 v[60:61], v101 offset:7168
    ds_read_b64_tr_b16 v[62:63], v101 offset:7296
    s_waitcnt lgkmcnt(12)
    v_mfma_f32_16x16x32_bf16 v[144:147], v[32:35], v[112:115], 0
    v_mfma_f32_16x16x32_bf16 v[144:147], v[36:39], v[116:119], v[144:147]
    s_waitcnt lgkmcnt(8)
    v_mfma_f32_16x16x32_bf16 v[148:151], v[40:43], v[120:123], 0
    v_mfma_f32_16x16x32_bf16 v[148:151], v[44:47], v[124:127], v[148:151]
    s_cmp_eq_u32 s48, 0
    s_cbranch_scc1 L_rho0_88
    s_waitcnt lgkmcnt(4)
    v_mfma_f32_16x16x32_bf16 v[152:155], v[48:51], v[120:123], 0
    v_mfma_f32_16x16x32_bf16 v[152:155], v[52:55], v[124:127], v[152:155]
    s_waitcnt lgkmcnt(0)
    v_mfma_f32_16x16x32_bf16 v[148:151], v[56:59], v[112:115], v[148:151]
    v_mfma_f32_16x16x32_bf16 v[148:151], v[60:63], v[116:119], v[148:151]
    s_nop 4
    v_pk_add_f32 v[144:145], v[144:145], v[152:153] neg_lo:[0,1] neg_hi:[0,1]
    v_pk_add_f32 v[146:147], v[146:147], v[154:155] neg_lo:[0,1] neg_hi:[0,1]
    s_nop 0
    v_pk_add_f32 v[160:161], v[144:145], v[148:149] neg_lo:[0,1] neg_hi:[0,1]
    v_pk_add_f32 v[168:169], v[144:145], v[148:149]
    v_pk_add_f32 v[162:163], v[146:147], v[150:151] neg_lo:[0,1] neg_hi:[0,1]
    v_pk_add_f32 v[170:171], v[146:147], v[150:151]
    v_pk_add_f32 v[164:165], v[168:169], v[76:77]
    v_pk_add_f32 v[172:173], v[160:161], v[84:85]
    v_pk_add_f32 v[166:167], v[170:171], v[78:79]
    v_pk_add_f32 v[174:175], v[162:163], v[86:87]
    s_branch L_cj_89
L_rho0_88:
    s_waitcnt lgkmcnt(4)
    v_mfma_f32_16x16x32_bf16 v[152:155], v[48:51], v[128:131], 0
    v_mfma_f32_16x16x32_bf16 v[152:155], v[52:55], v[132:135], v[152:155]
    s_waitcnt lgkmcnt(0)
    v_mfma_f32_16x16x32_bf16 v[156:159], v[56:59], v[136:139], 0
    v_mfma_f32_16x16x32_bf16 v[156:159], v[60:63], v[140:143], v[156:159]
    v_pk_add_f32 v[160:161], v[144:145], v[148:149] neg_lo:[0,1] neg_hi:[0,1]
    v_pk_add_f32 v[164:165], v[144:145], v[148:149]
    s_nop 5
    v_pk_add_f32 v[168:169], v[152:153], v[156:157] neg_lo:[0,1] neg_hi:[0,1]
    v_pk_add_f32 v[172:173], v[152:153], v[156:157]
    v_pk_add_f32 v[162:163], v[146:147], v[150:151] neg_lo:[0,1] neg_hi:[0,1]
    v_pk_add_f32 v[166:167], v[146:147], v[150:151]
    v_pk_add_f32 v[170:171], v[154:155], v[158:159] neg_lo:[0,1] neg_hi:[0,1]
    v_pk_add_f32 v[174:175], v[154:155], v[158:159]
    v_pk_add_f32 v[164:165], v[164:165], v[76:77]
    v_pk_add_f32 v[172:173], v[172:173], v[84:85]
    v_pk_add_f32 v[166:167], v[166:167], v[78:79]
    v_pk_add_f32 v[174:175], v[174:175], v[86:87]
L_cj_89:
    v_fma_f32 v160, v160, v102, v72
    v_add_f32 v161, v161, v73
    v_pk_add_f32 v[162:163], v[162:163], v[74:75]
    v_fma_f32 v168, v168, v102, v80
    v_add_f32 v169, v169, v81
    v_pk_add_f32 v[170:171], v[170:171], v[82:83]
    v_cvt_pk_bf16_f32 v176, v160, v161
    v_cvt_pk_bf16_f32 v177, v162, v163
    v_cvt_pk_bf16_f32 v178, v164, v165
    v_cvt_pk_bf16_f32 v179, v166, v167
    v_cvt_pk_bf16_f32 v180, v168, v169
    v_cvt_pk_bf16_f32 v181, v170, v171
    v_cvt_pk_bf16_f32 v182, v172, v173
    v_cvt_pk_bf16_f32 v183, v174, v175
    s_cmp_eq_u32 s52, 0
    s_cbranch_scc0 L_slow_90
    buffer_store_dwordx4 v[176:179], v96, s[4:7], s30 offen
    buffer_store_dwordx4 v[180:183], v97, s[4:7], s30 offen
    s_branch L_done_91
L_slow_90:
    buffer_store_dwordx4 v[176:179], v96, s[4:7], s30 offen sc1
    buffer_store_dwordx4 v[180:183], v97, s[4:7], s30 offen sc1
L_done_91:
    v_pk_add_f32 v[144:145], v[160:161], v[162:163]
    v_pk_mul_f32 v[146:147], v[160:161], v[160:161]
    v_pk_add_f32 v[144:145], v[144:145], v[164:165]
    v_pk_fma_f32 v[146:147], v[162:163], v[162:163], v[146:147]
    v_pk_add_f32 v[144:145], v[144:145], v[166:167]
    v_pk_fma_f32 v[146:147], v[164:165], v[164:165], v[146:147]
    v_pk_fma_f32 v[146:147], v[166:167], v[166:167], v[146:147]
    v_add_f32 v144, v144, v145
    v_add_f32 v146, v146, v147
    v_pk_add_f32 v[148:149], v[168:169], v[170:171]
    v_pk_mul_f32 v[150:151], v[168:169], v[168:169]
    v_pk_add_f32 v[148:149], v[148:149], v[172:173]
    v_pk_fma_f32 v[150:151], v[170:171], v[170:171], v[150:151]
    v_pk_add_f32 v[148:149], v[148:149], v[174:175]
    v_pk_fma_f32 v[150:151], v[172:173], v[172:173], v[150:151]
    v_pk_fma_f32 v[150:151], v[174:175], v[174:175], v[150:151]
    v_add_f32 v148, v148, v149
    v_add_f32 v150, v150, v151
    v_permlane32_swap_b32 v144, v146
    s_nop 0
    v_permlane32_swap_b32 v148, v150
    v_add_f32 v144, v144, v146
    v_add_f32 v148, v148, v150
    s_nop 1
    v_permlane16_swap_b32 v144, v148
    v_add_f32 v144, v144, v148
    s_cmp_eq_u32 s52, 0
    s_cbranch_scc0 L_slow_92
    buffer_store_dword v144, v98, s[4:7], s31 offen
    s_branch L_done_93
L_slow_92:
    buffer_store_dword v144, v98, s[4:7], s31 offen sc1
L_done_93:
L_g4skip_83:
    s_setprio 2
L_p1_94:
    ds_read_b64_tr_b16 a[0:1], v4 offset:0
    ds_read_b64_tr_b16 a[2:3], v5 offset:13824
    ds_read_b64_tr_b16 a[4:5], v4 offset:28800
    ds_read_b64_tr_b16 a[6:7], v5 offset:42624
    ds_read_b64_tr_b16 a[8:9], v4 offset:512
    ds_read_b64_tr_b16 a[10:11], v5 offset:13312
    ds_read_b64_tr_b16 a[12:13], v4 offset:29312
    ds_read_b64_tr_b16 a[14:15], v5 offset:42112
    ds_read_b64_tr_b16 a[16:17], v4 offset:1024
    ds_read_b64_tr_b16 a[18:19], v5 offset:12800
    ds_read_b64_tr_b16 a[20:21], v4 offset:29824
    ds_read_b64_tr_b16 a[22:23], v5 offset:41600
L_xpoll_95:
    buffer_load_dword v13, v31, s[4:7], s16 offen sc1
    s_add_u32 s54, s16, 65536
    buffer_load_dwordx4 v[32:35], v1, s[4:7], s54 offen offset:0 sc1
    buffer_load_dwordx4 v[36:39], v1, s[4:7], s54 offen offset:1024 sc1
    s_waitcnt vmcnt(0)
    v_max3_u32 v13, v13, v32, v36
    v_cmp_eq_u32 vcc, -1, v13
    s_nop 0
    s_cbranch_vccz L_ok_96
    s_cmp_eq_u32 s53, 0
    s_cbranch_scc1 L_ok_96
    s_sub_u32 s53, s53, 1
    s_branch L_xpoll_95
L_ok_96:
    buffer_load_dwordx4 v[40:43], v1, s[4:7], s54 offen offset:2048 sc1
    buffer_load_dwordx4 v[44:47], v1, s[4:7], s54 offen offset:3072 sc1
    s_add_u32 s54, s16, 69632
    buffer_load_dwordx4 v[48:51], v1, s[4:7], s54 offen offset:0 sc1
    buffer_load_dwordx4 v[52:55], v1, s[4:7], s54 offen offset:1024 sc1
    buffer_load_dwordx4 v[56:59], v1, s[4:7], s54 offen offset:2048 sc1
    buffer_load_dwordx4 v[60:63], v1, s[4:7], s54 offen offset:3072 sc1
    v_mov_b32 v18, 0
    s_add_u32 s62, s16, 94208
    s_waitcnt vmcnt(7) lgkmcnt(8)
    v_mfma_f32_32x32x16_bf16 v[144:159], a[0:3], v[32:35], 0
    s_add_u32 s54, s16, 73728
    buffer_load_dwordx4 v[64:67], v1, s[4:7], s54 offen offset:0 sc1
    v_mfma_f32_32x32x16_bf16 v[160:175], a[4:7], v[32:35], 0
    ds_read_b64_tr_b16 a[24:25], v4 offset:1536
    ds_read_b64_tr_b16 a[26:27], v5 offset:12288
    ds_read_b64_tr_b16 a[28:29], v4 offset:30336
    ds_read_b64_tr_b16 a[30:31], v5 offset:41088
    s_waitcnt vmcnt(7) lgkmcnt(8)
    v_mfma_f32_32x32x16_bf16 v[144:159], a[8:11], v[36:39], v[144:159]
    buffer_load_dwordx4 v[68:71], v1, s[4:7], s54 offen offset:1024 sc1
    v_mfma_f32_32x32x16_bf16 v[160:175], a[12:15], v[36:39], v[160:175]
    ds_read_b64_tr_b16 a[0:1], v4 offset:2048
    ds_read_b64_tr_b16 a[2:3], v5 offset:11776
    ds_read_b64_tr_b16 a[4:5], v4 offset:30848
    ds_read_b64_tr_b16 a[6:7], v5 offset:40576
    v_max3_u32 v18, v18, v36, v32
    s_waitcnt vmcnt(7) lgkmcnt(8)
    v_mfma_f32_32x32x16_bf16 v[144:159], a[16:19], v[40:43], v[144:159]
    buffer_load_dwordx4 v[72:75], v1, s[4:7], s54 offen offset:2048 sc1
    v_mfma_f32_32x32x16_bf16 v[160:175], a[20:23], v[40:43], v[160:175]
    ds_read_b64_tr_b16 a[8:9], v4 offset:2560
    ds_read_b64_tr_b16 a[10:11], v5 offset:11264
    ds_read_b64_tr_b16 a[12:13], v4 offset:31360
    ds_read_b64_tr_b16 a[14:15], v5 offset:40064
    s_waitcnt vmcnt(7) lgkmcnt(8)
    v_mfma_f32_32x32x16_bf16 v[144:159], a[24:27], v[44:47], v[144:159]
    buffer_load_dwordx4 v[76:79], v1, s[4:7], s54 offen offset:3072 sc1
    v_mfma_f32_32x32x16_bf16 v[160:175], a[28:31], v[44:47], v[160:175]
    ds_read_b64_tr_b16 a[16:17], v4 offset:3072
    ds_read_b64_tr_b16 a[18:19], v5 offset:10752
    ds_read_b64_tr_b16 a[20:21], v4 offset:31872
    ds_read_b64_tr_b16 a[22:23], v5 offset:39552
    v_max3_u32 v18, v18, v44, v40
    s_waitcnt vmcnt(7) lgkmcnt(8)
    v_mfma_f32_32x32x16_bf16 v[144:159], a[0:3], v[48:51], v[144:159]
    s_add_u32 s54, s16, 77824
    buffer_load_dwordx4 v[80:83], v1, s[4:7], s54 offen offset:0 sc1
    buffer_load_dwordx4 v[176:179], v1, s[4:7], s62 offen offset:0 sc1
    buffer_load_dwordx4 v[180:183], v1, s[4:7], s62 offen offset:1024 sc1
    buffer_load_dwordx4 v[184:187], v1, s[4:7], s62 offen offset:2048 sc1
    buffer_load_dwordx4 v[188:191], v1, s[4:7], s62 offen offset:3072 sc1
    v_mfma_f32_32x32x16_bf16 v[160:175], a[4:7], v[48:51], v[160:175]
    ds_read_b64_tr_b16 a[24:25], v4 offset:3584
    ds_read_b64_tr_b16 a[26:27], v5 offset:10240
    ds_read_b64_tr_b16 a[28:29], v4 offset:32384
    ds_read_b64_tr_b16 a[30:31], v5 offset:39040
    s_waitcnt vmcnt(11) lgkmcnt(8)
    v_mfma_f32_32x32x16_bf16 v[144:159], a[8:11], v[52:55], v[144:159]
    buffer_load_dwordx4 v[84:87], v1, s[4:7], s54 offen offset:1024 sc1
    v_mfma_f32_32x32x16_bf16 v[160:175], a[12:15], v[52:55], v[160:175]
    ds_read_b64_tr_b16 a[0:1], v4 offset:4096
    ds_read_b64_tr_b16 a[2:3], v5 offset:9728
    ds_read_b64_tr_b16 a[4:5], v4 offset:32896
    ds_read_b64_tr_b16 a[6:7], v5 offset:38528
    v_max3_u32 v18, v18, v52, v48
    s_waitcnt vmcnt(11) lgkmcnt(8)
    v_mfma_f32_32x32x16_bf16 v[144:159], a[16:19], v[56:59], v[144:159]
    buffer_load_dwordx4 v[88:91], v1, s[4:7], s54 offen offset:2048 sc1
    v_mfma_f32_32x32x16_bf16 v[160:175], a[20:23], v[56:59], v[160:175]
    ds_read_b64_tr_b16 a[8:9], v4 offset:4608
    ds_read_b64_tr_b16 a[10:11], v5 offset:9216
    ds_read_b64_tr_b16 a[12:13], v4 offset:33408
    ds_read_b64_tr_b16 a[14:15], v5 offset:38016
    s_waitcnt vmcnt(11) lgkmcnt(8)
    v_mfma_f32_32x32x16_bf16 v[144:159], a[24:27], v[60:63], v[144:159]
    buffer_load_dwordx4 v[92:95], v1, s[4:7], s54 offen offset:3072 sc1
    v_mfma_f32_32x32x16_bf16 v[160:175], a[28:31], v[60:63], v[160:175]
    ds_read_b64_tr_b16 a[16:17], v4 offset:5120
    ds_read_b64_tr_b16 a[18:19], v5 offset:8704
    ds_read_b64_tr_b16 a[20:21], v4 offset:33920
    ds_read_b64_tr_b16 a[22:23], v5 offset:37504
    v_max3_u32 v18, v18, v60, v56
    s_waitcnt vmcnt(11) lgkmcnt(8)
    v_mfma_f32_32x32x16_bf16 v[144:159], a[0:3], v[64:67], v[144:159]
    s_add_u32 s54, s16, 81920
    buffer_load_dwordx4 v[96:99], v1, s[4:7], s54 offen offset:0 sc1
    v_mfma_f32_32x32x16_bf16 v[160:175], a[4:7], v[64:67], v[160:175]
    ds_read_b64_tr_b16 a[24:25], v4 offset:5632
    ds_read_b64_tr_b16 a[26:27], v5 offset:8192
    ds_read_b64_tr_b16 a[28:29], v4 offset:34432
    ds_read_b64_tr_b16 a[30:31], v5 offset:36992
    s_waitcnt vmcnt(11) lgkmcnt(8)
    v_mfma_f32_32x32x16_bf16 v[144:159], a[8:11], v[68:71], v[144:159]
    buffer_load_dwordx4 v[100:103], v1, s[4:7], s54 offen offset:1024 sc1
    v_mfma_f32_32x32x16_bf16 v[160:175], a[12:15], v[68:71], v[160:175]
    ds_read_b64_tr_b16 a[0:1], v4 offset:6144
    ds_read_b64_tr_b16 a[2:3], v5 offset:7680
    ds_read_b64_tr_b16 a[4:5], v4 offset:34944
    ds_read_b64_tr_b16 a[6:7], v5 offset:36480
    v_max3_u32 v18, v18, v68, v64
    s_waitcnt vmcnt(11) lgkmcnt(8)
    v_mfma_f32_32x32x16_bf16 v[144:159], a[16:19], v[72:75], v[144:159]
    buffer_load_dwordx4 v[104:107], v1, s[4:7], s54 offen offset:2048 sc1
    v_mfma_f32_32x32x16_bf16 v[160:175], a[20:23], v[72:75], v[160:175]
    ds_read_b64_tr_b16 a[8:9], v4 offset:6656
    ds_read_b64_tr_b16 a[10:11], v5 offset:7168
    ds_read_b64_tr_b16 a[12:13], v4 offset:35456
    ds_read_b64_tr_b16 a[14:15], v5 offset:35968
    s_waitcnt vmcnt(11) lgkmcnt(8)
    v_mfma_f32_32x32x16_bf16 v[144:159], a[24:27], v[76:79], v[144:159]
    buffer_load_dwordx4 v[108:111], v1, s[4:7], s54 offen offset:3072 sc1
    v_mfma_f32_32x32x16_bf16 v[160:175], a[28:31], v[76:79], v[160:175]
    ds_read_b64_tr_b16 a[16:17], v4 offset:7168
    ds_read_b64_tr_b16 a[18:19], v5 offset:6656
    ds_read_b64_tr_b16 a[20:21], v4 offset:35968
    ds_read_b64_tr_b16 a[22:23], v5 offset:35456
    v_max3_u32 v18, v18, v76, v72
    s_waitcnt vmcnt(11) lgkmcnt(8)
    v_mfma_f32_32x32x16_bf16 v[144:159], a[0:3], v[80:83], v[144:159]
    s_add_u32 s54, s16, 86016
    buffer_load_dwordx4 v[112:115], v1, s[4:7], s54 offen offset:0 sc1
    v_mfma_f32_32x32x16_bf16 v[160:175], a[4:7], v[80:83], v[160:175]
    ds_read_b64_tr_b16 a[24:25], v4 offset:7680
    ds_read_b64_tr_b16 a[26:27], v5 offset:6144
    ds_read_b64_tr_b16 a[28:29], v4 offset:36480
    ds_read_b64_tr_b16 a[30:31], v5 offset:34944
    s_waitcnt vmcnt(7) lgkmcnt(8)
    v_mfma_f32_32x32x16_bf16 v[144:159], a[8:11], v[84:87], v[144:159]
    buffer_load_dwordx4 v[116:119], v1, s[4:7], s54 offen offset:1024 sc1
    v_max3_u32 v19, v176, v177, v178
    v_max3_u32 v19, v19, v179, v180
    v_max3_u32 v19, v19, v181, v182
    v_mfma_f32_32x32x16_bf16 v[160:175], a[12:15], v[84:87], v[160:175]
    ds_read_b64_tr_b16 a[0:1], v4 offset:8192
    ds_read_b64_tr_b16 a[2:3], v5 offset:5632
    ds_read_b64_tr_b16 a[4:5], v4 offset:36992
    ds_read_b64_tr_b16 a[6:7], v5 offset:34432
    v_max3_u32 v18, v18, v84, v80
    s_waitcnt vmcnt(7) lgkmcnt(8)
    v_mfma_f32_32x32x16_bf16 v[144:159], a[16:19], v[88:91], v[144:159]
    buffer_load_dwordx4 v[120:123], v1, s[4:7], s54 offen offset:2048 sc1
    v_max3_u32 v19, v19, v183, v184
    v_max3_u32 v19, v19, v185, v186
    v_max3_u32 v19, v19, v187, v188
    v_mfma_f32_32x32x16_bf16 v[160:175], a[20:23], v[88:91], v[160:175]
    ds_read_b64_tr_b16 a[8:9], v4 offset:8704
    ds_read_b64_tr_b16 a[10:11], v5 offset:5120
    ds_read_b64_tr_b16 a[12:13], v4 offset:37504
    ds_read_b64_tr_b16 a[14:15], v5 offset:33920
    s_waitcnt vmcnt(7) lgkmcnt(8)
    v_mfma_f32_32x32x16_bf16 v[144:159], a[24:27], v[92:95], v[144:159]
    buffer_load_dwordx4 v[124:127], v1, s[4:7], s54 offen offset:3072 sc1
    v_max_u32 v19, v19, v189
    v_add_f32 v176, v176, v177
    v_add_f32 v178, v178, v179
    v_mfma_f32_32x32x16_bf16 v[160:175], a[28:31], v[92:95], v[160:175]
    ds_read_b64_tr_b16 a[16:17], v4 offset:9216
    ds_read_b64_tr_b16 a[18:19], v5 offset:4608
    ds_read_b64_tr_b16 a[20:21], v4 offset:38016
    ds_read_b64_tr_b16 a[22:23], v5 offset:33408
    v_max3_u32 v18, v18, v92, v88
    s_waitcnt vmcnt(7) lgkmcnt(8)
    v_mfma_f32_32x32x16_bf16 v[144:159], a[0:3], v[96:99], v[144:159]
    s_add_u32 s54, s16, 90112
    buffer_load_dwordx4 v[128:131], v1, s[4:7], s54 offen offset:0 sc1
    v_add_f32 v180, v180, v181
    v_add_f32 v182, v182, v183
    v_add_f32 v184, v184, v185
    v_mfma_f32_32x32x16_bf16 v[160:175], a[4:7], v[96:99], v[160:175]
    ds_read_b64_tr_b16 a[24:25], v4 offset:9728
    ds_read_b64_tr_b16 a[26:27], v5 offset:4096
    ds_read_b64_tr_b16 a[28:29], v4 offset:38528
    ds_read_b64_tr_b16 a[30:31], v5 offset:32896
    s_waitcnt vmcnt(7) lgkmcnt(8)
    v_mfma_f32_32x32x16_bf16 v[144:159], a[8:11], v[100:103], v[144:159]
    buffer_load_dwordx4 v[132:135], v1, s[4:7], s54 offen offset:1024 sc1
    v_add_f32 v186, v186, v187
    v_add_f32 v188, v188, v189
    v_add_f32 v176, v176, v178
    v_mfma_f32_32x32x16_bf16 v[160:175], a[12:15], v[100:103], v[160:175]
    ds_read_b64_tr_b16 a[0:1], v4 offset:10240
    ds_read_b64_tr_b16 a[2:3], v5 offset:3584
    ds_read_b64_tr_b16 a[4:5], v4 offset:39040
    ds_read_b64_tr_b16 a[6:7], v5 offset:32384
    v_max3_u32 v18, v18, v100, v96
    s_waitcnt vmcnt(7) lgkmcnt(8)
    v_mfma_f32_32x32x16_bf16 v[144:159], a[16:19], v[104:107], v[144:159]
    buffer_load_dwordx4 v[136:139], v1, s[4:7], s54 offen offset:2048 sc1
    v_add_f32 v180, v180, v182
    v_add_f32 v184, v184, v186
    v_add_f32 v176, v176, v180
    v_mfma_f32_32x32x16_bf16 v[160:175], a[20:23], v[104:107], v[160:175]
    ds_read_b64_tr_b16 a[8:9], v4 offset:10752
    ds_read_b64_tr_b16 a[10:11], v5 offset:3072
    ds_read_b64_tr_b16 a[12:13], v4 offset:39552
    ds_read_b64_tr_b16 a[14:15], v5 offset:31872
    s_waitcnt vmcnt(7) lgkmcnt(8)
    v_mfma_f32_32x32x16_bf16 v[144:159], a[24:27], v[108:111], v[144:159]
    buffer_load_dwordx4 v[140:143], v1, s[4:7], s54 offen offset:3072 sc1
    v_add_f32 v184, v184, v188
    v_add_f32 v176, v176, v184
    v_mul_f32 v176, 0x3b124925, v176
    v_mfma_f32_32x32x16_bf16 v[160:175], a[28:31], v[108:111], v[160:175]
    ds_read_b64_tr_b16 a[16:17], v4 offset:11264
    ds_read_b64_tr_b16 a[18:19], v5 offset:2560
    ds_read_b64_tr_b16 a[20:21], v4 offset:40064
    ds_read_b64_tr_b16 a[22:23], v5 offset:31360
    v_max3_u32 v18, v18, v108, v104
    s_waitcnt vmcnt(7) lgkmcnt(8)
    v_mfma_f32_32x32x16_bf16 v[144:159], a[0:3], v[112:115], v[144:159]
    v_mov_b32 v177, v176
    s_nop 1
    v_permlane32_swap_b32 v176, v177
    v_fma_f32 v177, -v176, v176, v177
    v_mfma_f32_32x32x16_bf16 v[160:175], a[4:7], v[112:115], v[160:175]
    ds_read_b64_tr_b16 a[24:25], v4 offset:11776
    ds_read_b64_tr_b16 a[26:27], v5 offset:2048
    ds_read_b64_tr_b16 a[28:29], v4 offset:40576
    ds_read_b64_tr_b16 a[30:31], v5 offset:30848
    s_waitcnt vmcnt(6) lgkmcnt(8)
    v_mfma_f32_32x32x16_bf16 v[144:159], a[8:11], v[116:119], v[144:159]
    v_sub_f32 v12, 0, v176
    v_max_f32 v177, 0, v177
    v_add_f32 v177, 0x3727c5ac, v177
    v_mfma_f32_32x32x16_bf16 v[160:175], a[12:15], v[116:119], v[160:175]
    ds_read_b64_tr_b16 a[0:1], v4 offset:12288
    ds_read_b64_tr_b16 a[2:3], v5 offset:1536
    ds_read_b64_tr_b16 a[4:5], v4 offset:41088
    ds_read_b64_tr_b16 a[6:7], v5 offset:30336
    v_max3_u32 v18, v18, v116, v112
    s_waitcnt vmcnt(5) lgkmcnt(8)
    v_mfma_f32_32x32x16_bf16 v[144:159], a[16:19], v[120:123], v[144:159]
    v_rsq_f32 v14, v177
    v_mfma_f32_32x32x16_bf16 v[160:175], a[20:23], v[120:123], v[160:175]
    ds_read_b64_tr_b16 a[8:9], v4 offset:12800
    ds_read_b64_tr_b16 a[10:11], v5 offset:1024
    ds_read_b64_tr_b16 a[12:13], v4 offset:41600
    ds_read_b64_tr_b16 a[14:15], v5 offset:29824
    s_waitcnt vmcnt(4) lgkmcnt(8)
    v_mfma_f32_32x32x16_bf16 v[144:159], a[24:27], v[124:127], v[144:159]
    v_mfma_f32_32x32x16_bf16 v[160:175], a[28:31], v[124:127], v[160:175]
    ds_read_b64_tr_b16 a[16:17], v4 offset:13312
    ds_read_b64_tr_b16 a[18:19], v5 offset:512
    ds_read_b64_tr_b16 a[20:21], v4 offset:42112
    ds_read_b64_tr_b16 a[22:23], v5 offset:29312
    v_max3_u32 v18, v18, v124, v120
    s_waitcnt vmcnt(3) lgkmcnt(8)
    v_mfma_f32_32x32x16_bf16 v[144:159], a[0:3], v[128:131], v[144:159]
    v_mfma_f32_32x32x16_bf16 v[160:175], a[4:7], v[128:131], v[160:175]
    ds_read_b64_tr_b16 a[24:25], v4 offset:13824
    ds_read_b64_tr_b16 a[26:27], v5 offset:0
    ds_read_b64_tr_b16 a[28:29], v4 offset:42624
    ds_read_b64_tr_b16 a[30:31], v5 offset:28800
    s_waitcnt vmcnt(2) lgkmcnt(8)
    v_mfma_f32_32x32x16_bf16 v[144:159], a[8:11], v[132:135], v[144:159]
    v_mfma_f32_32x32x16_bf16 v[160:175], a[12:15], v[132:135], v[160:175]
    ds_read_b128 v[176:179], v10 offset:128
    ds_read_b128 v[180:183], v10 offset:160
    ds_read_b128 v[184:187], v10 offset:192
    ds_read_b128 v[188:191], v10 offset:224
    ds_read_b128 v[192:195], v10 offset:256
    ds_read_b128 v[196:199], v10 offset:288
    ds_read_b128 v[200:203], v10 offset:320
    ds_read_b128 v[204:207], v10 offset:352
    v_max3_u32 v18, v18, v132, v128
    s_waitcnt vmcnt(1) lgkmcnt(12)
    v_mfma_f32_32x32x16_bf16 v[144:159], a[16:19], v[136:139], v[144:159]
    v_mfma_f32_32x32x16_bf16 v[160:175], a[20:23], v[136:139], v[160:175]
    s_waitcnt vmcnt(0) lgkmcnt(8)
    v_mfma_f32_32x32x16_bf16 v[144:159], a[24:27], v[140:143], v[144:159]
    v_mfma_f32_32x32x16_bf16 v[160:175], a[28:31], v[140:143], v[160:175]
    v_max3_u32 v18, v18, v140, v136
    v_max_u32 v18, v18, v19
    v_cmp_eq_u32 vcc, -1, v18
    s_nop 0
    s_cbranch_vccz L_ok_97
    s_cmp_eq_u32 s53, 0
    s_cbranch_scc1 L_ok_97
    s_sub_u32 s53, s53, 1
    s_waitcnt lgkmcnt(0)
    s_branch L_p1_94
L_ok_97:
    s_waitcnt lgkmcnt(4)
    s_nop 4
    v_pk_fma_f32 v[144:145], v[176:177], v[12:13], v[144:145] op_sel_hi:[1,0,1]
    v_pk_fma_f32 v[146:147], v[178:179], v[12:13], v[146:147] op_sel_hi:[1,0,1]
    v_pk_fma_f32 v[148:149], v[180:181], v[12:13], v[148:149] op_sel_hi:[1,0,1]
    v_pk_fma_f32 v[150:151], v[182:183], v[12:13], v[150:151] op_sel_hi:[1,0,1]
    v_pk_fma_f32 v[152:153], v[184:185], v[12:13], v[152:153] op_sel_hi:[1,0,1]
    v_pk_fma_f32 v[154:155], v[186:187], v[12:13], v[154:155] op_sel_hi:[1,0,1]
    v_pk_fma_f32 v[156:157], v[188:189], v[12:13], v[156:157] op_sel_hi:[1,0,1]
    v_pk_fma_f32 v[158:159], v[190:191], v[12:13], v[158:159] op_sel_hi:[1,0,1]
    v_mul_f32 v16, 0x3fb8aa3b, v14
    v_cvt_pk_bf16_f32 v144, v144, v145
    v_cvt_pk_bf16_f32 v145, v146, v147
    v_cvt_pk_bf16_f32 v146, v148, v149
    v_cvt_pk_bf16_f32 v147, v150, v151
    v_cvt_pk_bf16_f32 v148, v152, v153
    v_cvt_pk_bf16_f32 v149, v154, v155
    v_cvt_pk_bf16_f32 v150, v156, v157
    v_cvt_pk_bf16_f32 v151, v158, v159
    s_waitcnt lgkmcnt(0)
    v_mul_f32 v18, v12, v14
    v_mfma_f32_32x32x16_bf16 v[176:191], a[32:35], v[144:147], 0
    v_mul_f32 v192, v18, v192
    v_mul_f32 v193, v18, v193
    v_mul_f32 v194, v18, v194
    v_mul_f32 v195, v18, v195
    v_mul_f32 v196, v18, v196
    v_mul_f32 v197, v18, v197
    v_mfma_f32_32x32x16_bf16 v[176:191], a[36:39], v[148:151], v[176:191]
    v_mul_f32 v198, v18, v198
    v_mul_f32 v199, v18, v199
    v_mul_f32 v200, v18, v200
    v_mul_f32 v201, v18, v201
    v_mul_f32 v202, v18, v202
    v_mul_f32 v203, v18, v203
    v_mul_f32 v204, v18, v204
    v_mul_f32 v205, v18, v205
    v_mul_f32 v206, v18, v206
    v_mul_f32 v207, v18, v207
    v_pk_fma_f32 v[160:161], v[160:161], v[14:15], v[192:193] op_sel_hi:[1,0,1]
    v_pk_fma_f32 v[162:163], v[162:163], v[14:15], v[194:195] op_sel_hi:[1,0,1]
    v_pk_fma_f32 v[164:165], v[164:165], v[14:15], v[196:197] op_sel_hi:[1,0,1]
    v_pk_fma_f32 v[166:167], v[166:167], v[14:15], v[198:199] op_sel_hi:[1,0,1]
    v_pk_fma_f32 v[168:169], v[168:169], v[14:15], v[200:201] op_sel_hi:[1,0,1]
    v_pk_fma_f32 v[170:171], v[170:171], v[14:15], v[202:203] op_sel_hi:[1,0,1]
    v_pk_fma_f32 v[172:173], v[172:173], v[14:15], v[204:205] op_sel_hi:[1,0,1]
    v_pk_fma_f32 v[174:175], v[174:175], v[14:15], v[206:207] op_sel_hi:[1,0,1]
    v_cndmask_b32_e64 v172, v172, 1.0, s[66:67]
    v_cvt_pk_bf16_f32 v160, v160, v161
    v_cvt_pk_bf16_f32 v161, v162, v163
    v_cvt_pk_bf16_f32 v162, v164, v165
    v_cvt_pk_bf16_f32 v163, v166, v167
    v_cvt_pk_bf16_f32 v164, v168, v169
    v_cvt_pk_bf16_f32 v165, v170, v171
    v_cvt_pk_bf16_f32 v166, v172, v173
    v_cvt_pk_bf16_f32 v167, v174, v175
    ds_write_b128 v8, v[160:163] offset:128
    ds_write_b128 v8, v[164:167] offset:144
    v_max3_f32 v18, v176, v177, v178
    v_max3_f32 v19, -v176, -v177, -v178
    v_max3_f32 v18, v18, v179, v180
    v_max3_f32 v19, v19, -v179, -v180
    v_max3_f32 v18, v18, v181, v182
    v_max3_f32 v19, v19, -v181, -v182
    v_max3_f32 v18, v18, v184, v185
    v_max3_f32 v19, v19, -v184, -v185
    v_max3_f32 v18, v18, v186, v187
    v_max3_f32 v19, v19, -v186, -v187
    v_max3_f32 v18, v18, v188, v189
    v_max3_f32 v19, v19, -v188, -v189
    v_max_f32 v18, v18, v190
    v_max_f32_e64 v19, v19, -v190
    s_nop 1
    v_permlane32_swap_b32 v18, v19
    v_max_f32 v18, v18, v19
    v_mul_f32_e64 v20, -v18, v16
    v_mul_f32_e64 v22, -v18, v16
    s_nop 1
    v_permlane32_swap_b32 v20, v22
    v_pk_fma_f32 v[192:193], v[176:177], v[16:17], v[20:21] op_sel_hi:[1,0,0]
    v_pk_fma_f32 v[194:195], v[178:179], v[16:17], v[20:21] op_sel_hi:[1,0,0]
    v_pk_fma_f32 v[196:197], v[180:181], v[16:17], v[20:21] op_sel_hi:[1,0,0]
    v_pk_fma_f32 v[200:201], v[184:185], v[16:17], v[20:21] op_sel_hi:[1,0,0]
    v_pk_fma_f32 v[202:203], v[186:187], v[16:17], v[20:21] op_sel_hi:[1,0,0]
    v_pk_fma_f32 v[204:205], v[188:189], v[16:17], v[20:21] op_sel_hi:[1,0,0]
    v_fma_f32 v198, v182, v16, v20
    v_fma_f32 v206, v190, v16, v20
    v_exp_f32 v192, v192
    v_exp_f32 v193, v193
    v_exp_f32 v194, v194
    v_exp_f32 v195, v195
    v_exp_f32 v196, v196
    v_exp_f32 v197, v197
    v_exp_f32 v198, v198
    v_exp_f32 v200, v200
    v_exp_f32 v201, v201
    v_exp_f32 v202, v202
    v_exp_f32 v203, v203
    v_exp_f32 v204, v204
    v_exp_f32 v205, v205
    v_exp_f32 v206, v206
    v_pk_fma_f32 v[176:177], v[176:177], v[16:17], v[22:23] op_sel_hi:[1,0,0] neg_lo:[1,0,0] neg_hi:[1,0,0]
    v_pk_fma_f32 v[178:179], v[178:179], v[16:17], v[22:23] op_sel_hi:[1,0,0] neg_lo:[1,0,0] neg_hi:[1,0,0]
    v_pk_fma_f32 v[180:181], v[180:181], v[16:17], v[22:23] op_sel_hi:[1,0,0] neg_lo:[1,0,0] neg_hi:[1,0,0]
    v_pk_fma_f32 v[184:185], v[184:185], v[16:17], v[22:23] op_sel_hi:[1,0,0] neg_lo:[1,0,0] neg_hi:[1,0,0]
    v_pk_fma_f32 v[186:187], v[186:187], v[16:17], v[22:23] op_sel_hi:[1,0,0] neg_lo:[1,0,0] neg_hi:[1,0,0]
    v_pk_fma_f32 v[188:189], v[188:189], v[16:17], v[22:23] op_sel_hi:[1,0,0] neg_lo:[1,0,0] neg_hi:[1,0,0]
    v_fma_f32 v182, -v182, v16, v22
    v_fma_f32 v190, -v190, v16, v22
    v_exp_f32 v176, v176
    v_exp_f32 v177, v177
    v_exp_f32 v178, v178
    v_exp_f32 v179, v179
    v_exp_f32 v180, v180
    v_exp_f32 v181, v181
    v_exp_f32 v182, v182
    v_exp_f32 v184, v184
    v_exp_f32 v185, v185
    v_exp_f32 v186, v186
    v_exp_f32 v187, v187
    v_exp_f32 v188, v188
    v_exp_f32 v189, v189
    v_exp_f32 v190, v190
    v_pk_add_f32 v[20:21], v[192:193], v[194:195]
    v_pk_add_f32 v[22:23], v[176:177], v[178:179]
    v_pk_add_f32 v[20:21], v[20:21], v[196:197]
    v_pk_add_f32 v[22:23], v[22:23], v[180:181]
    v_pk_add_f32 v[20:21], v[20:21], v[200:201]
    v_pk_add_f32 v[22:23], v[22:23], v[184:185]
    v_pk_add_f32 v[20:21], v[20:21], v[202:203]
    v_pk_add_f32 v[22:23], v[22:23], v[186:187]
    v_pk_add_f32 v[20:21], v[20:21], v[204:205]
    v_pk_add_f32 v[22:23], v[22:23], v[188:189]
    v_add_f32 v20, v20, v198
    v_add_f32 v21, v21, v206
    v_add_f32 v22, v22, v182
    v_add_f32 v23, v23, v190
    v_add_f32 v20, v20, v21
    v_add_f32 v22, v22, v23
    s_nop 1
    v_permlane32_swap_b32 v20, v22
    v_add_f32 v18, v20, v22
    v_rcp_f32 v20, v18
    v_rcp_f32 v22, v18
    s_nop 1
    v_permlane32_swap_b32 v20, v22
    v_pk_mul_f32 v[192:193], v[192:193], v[20:21] op_sel_hi:[1,0]
    v_pk_mul_f32 v[194:195], v[194:195], v[20:21] op_sel_hi:[1,0]
    v_pk_mul_f32 v[196:197], v[196:197], v[20:21] op_sel_hi:[1,0]
    v_pk_mul_f32 v[200:201], v[200:201], v[20:21] op_sel_hi:[1,0]
    v_pk_mul_f32 v[202:203], v[202:203], v[20:21] op_sel_hi:[1,0]
    v_pk_mul_f32 v[204:205], v[204:205], v[20:21] op_sel_hi:[1,0]
    v_mul_f32 v198, v198, v20
    v_mul_f32 v206, v206, v20
    v_cvt_pk_bf16_f32 v144, v192, v193
    v_cvt_pk_bf16_f32 v145, v194, v195
    v_cvt_pk_bf16_f32 v146, v196, v197
    v_cvt_pk_bf16_f32 v147, v198, 0
    v_cvt_pk_bf16_f32 v148, v200, v201
    v_cvt_pk_bf16_f32 v149, v202, v203
    v_cvt_pk_bf16_f32 v150, v204, v205
    v_cvt_pk_bf16_f32 v151, v206, 0
    ds_write_b128 v8, v[144:147]
    ds_write_b128 v8, v[148:151] offset:16
    v_pk_mul_f32 v[176:177], v[176:177], v[22:23] op_sel_hi:[1,0]
    v_pk_mul_f32 v[178:179], v[178:179], v[22:23] op_sel_hi:[1,0]
    v_pk_mul_f32 v[180:181], v[180:181], v[22:23] op_sel_hi:[1,0]
    v_pk_mul_f32 v[184:185], v[184:185], v[22:23] op_sel_hi:[1,0]
    v_pk_mul_f32 v[186:187], v[186:187], v[22:23] op_sel_hi:[1,0]
    v_pk_mul_f32 v[188:189], v[188:189], v[22:23] op_sel_hi:[1,0]
    v_mul_f32 v182, v182, v22
    v_mul_f32 v190, v190, v22
    v_cvt_pk_bf16_f32 v152, v176, v177
    v_cvt_pk_bf16_f32 v153, v178, v179
    v_cvt_pk_bf16_f32 v154, v180, v181
    v_cvt_pk_bf16_f32 v155, v182, 0
    v_cvt_pk_bf16_f32 v156, v184, v185
    v_cvt_pk_bf16_f32 v157, v186, v187
    v_cvt_pk_bf16_f32 v158, v188, v189
    v_cvt_pk_bf16_f32 v159, v190, 0
    ds_write_b128 v8, v[152:155] offset:64
    ds_write_b128 v8, v[156:159] offset:80
    v_add_u32 v4, 60672, v4
    v_add_u32 v5, 60672, v5
    s_waitcnt lgkmcnt(0)
    s_barrier
    s_setprio 0
    s_barrier
    ds_read_b64_tr_b16 a[0:1], v4 offset:0
    ds_read_b64_tr_b16 a[2:3], v5 offset:13824
    ds_read_b64_tr_b16 a[4:5], v4 offset:512
    ds_read_b64_tr_b16 a[6:7], v5 offset:13312
    ds_read_b64_tr_b16 a[8:9], v4 offset:1024
    ds_read_b64_tr_b16 a[10:11], v5 offset:12800
    ds_read_b64_tr_b16 a[12:13], v4 offset:1536
    ds_read_b64_tr_b16 a[14:15], v5 offset:12288
    s_waitcnt lgkmcnt(6)
    v_mfma_f32_32x32x16_bf16 v[144:159], a[0:3], v[32:35], 0
    ds_read_b64_tr_b16 a[16:17], v4 offset:2048
    ds_read_b64_tr_b16 a[18:19], v5 offset:11776
    s_waitcnt lgkmcnt(6)
    v_mfma_f32_32x32x16_bf16 v[144:159], a[4:7], v[36:39], v[144:159]
    ds_read_b64_tr_b16 a[0:1], v4 offset:2560
    ds_read_b64_tr_b16 a[2:3], v5 offset:11264
    s_waitcnt lgkmcnt(6)
    v_mfma_f32_32x32x16_bf16 v[144:159], a[8:11], v[40:43], v[144:159]
    ds_read_b64_tr_b16 a[4:5], v4 offset:3072
    ds_read_b64_tr_b16 a[6:7], v5 offset:10752
    s_waitcnt lgkmcnt(6)
    v_mfma_f32_32x32x16_bf16 v[144:159], a[12:15], v[44:47], v[144:159]
    ds_read_b64_tr_b16 a[8:9], v4 offset:3584
    ds_read_b64_tr_b16 a[10:11], v5 offset:10240
    s_waitcnt lgkmcnt(6)
    v_mfma_f32_32x32x16_bf16 v[144:159], a[16:19], v[48:51], v[144:159]
    ds_read_b64_tr_b16 a[12:13], v4 offset:4096
    ds_read_b64_tr_b16 a[14:15], v5 offset:9728
    s_waitcnt lgkmcnt(6)
    v_mfma_f32_32x32x16_bf16 v[144:159], a[0:3], v[52:55], v[144:159]
    ds_read_b64_tr_b16 a[16:17], v4 offset:4608
    ds_read_b64_tr_b16 a[18:19], v5 offset:9216
    s_waitcnt lgkmcnt(6)
    v_mfma_f32_32x32x16_bf16 v[144:159], a[4:7], v[56:59], v[144:159]
    ds_read_b64_tr_b16 a[0:1], v4 offset:5120
    ds_read_b64_tr_b16 a[2:3], v5 offset:8704
    s_waitcnt lgkmcnt(6)
    v_mfma_f32_32x32x16_bf16 v[144:159], a[8:11], v[60:63], v[144:159]
    ds_read_b64_tr_b16 a[4:5], v4 offset:5632
    ds_read_b64_tr_b16 a[6:7], v5 offset:8192
    s_waitcnt lgkmcnt(6)
    v_mfma_f32_32x32x16_bf16 v[144:159], a[12:15], v[64:67], v[144:159]
    ds_read_b64_tr_b16 a[8:9], v4 offset:6144
    ds_read_b64_tr_b16 a[10:11], v5 offset:7680
    s_waitcnt lgkmcnt(6)
    v_mfma_f32_32x32x16_bf16 v[144:159], a[16:19], v[68:71], v[144:159]
    ds_read_b64_tr_b16 a[12:13], v4 offset:6656
    ds_read_b64_tr_b16 a[14:15], v5 offset:7168
    s_waitcnt lgkmcnt(6)
    v_mfma_f32_32x32x16_bf16 v[144:159], a[0:3], v[72:75], v[144:159]
    ds_read_b64_tr_b16 a[16:17], v4 offset:7168
    ds_read_b64_tr_b16 a[18:19], v5 offset:6656
    s_waitcnt lgkmcnt(6)
    v_mfma_f32_32x32x16_bf16 v[144:159], a[4:7], v[76:79], v[144:159]
    ds_read_b64_tr_b16 a[0:1], v4 offset:7680
    ds_read_b64_tr_b16 a[2:3], v5 offset:6144
    s_waitcnt lgkmcnt(6)
    v_mfma_f32_32x32x16_bf16 v[144:159], a[8:11], v[80:83], v[144:159]
    ds_read_b64_tr_b16 a[4:5], v4 offset:8192
    ds_read_b64_tr_b16 a[6:7], v5 offset:5632
    s_waitcnt lgkmcnt(6)
    v_mfma_f32_32x32x16_bf16 v[144:159], a[12:15], v[84:87], v[144:159]
    ds_read_b64_tr_b16 a[8:9], v4 offset:8704
    ds_read_b64_tr_b16 a[10:11], v5 offset:5120
    s_waitcnt lgkmcnt(6)
    v_mfma_f32_32x32x16_bf16 v[144:159], a[16:19], v[88:91], v[144:159]
    ds_read_b64_tr_b16 a[12:13], v4 offset:9216
    ds_read_b64_tr_b16 a[14:15], v5 offset:4608
    s_waitcnt lgkmcnt(6)
    v_mfma_f32_32x32x16_bf16 v[144:159], a[0:3], v[92:95], v[144:159]
    ds_read_b64_tr_b16 a[16:17], v4 offset:9728
    ds_read_b64_tr_b16 a[18:19], v5 offset:4096
    s_waitcnt lgkmcnt(6)
    v_mfma_f32_32x32x16_bf16 v[144:159], a[4:7], v[96:99], v[144:159]
    ds_read_b64_tr_b16 a[0:1], v4 offset:10240
    ds_read_b64_tr_b16 a[2:3], v5 offset:3584
    s_waitcnt lgkmcnt(6)
    v_mfma_f32_32x32x16_bf16 v[144:159], a[8:11], v[100:103], v[144:159]
    ds_read_b64_tr_b16 a[4:5], v4 offset:10752
    ds_read_b64_tr_b16 a[6:7], v5 offset:3072
    s_waitcnt lgkmcnt(6)
    v_mfma_f32_32x32x16_bf16 v[144:159], a[12:15], v[104:107], v[144:159]
    ds_read_b64_tr_b16 a[8:9], v4 offset:11264
    ds_read_b64_tr_b16 a[10:11], v5 offset:2560
    s_waitcnt lgkmcnt(6)
    v_mfma_f32_32x32x16_bf16 v[144:159], a[16:19], v[108:111], v[144:159]
    ds_read_b64_tr_b16 a[12:13], v4 offset:11776
    ds_read_b64_tr_b16 a[14:15], v5 offset:2048
    s_waitcnt lgkmcnt(6)
    v_mfma_f32_32x32x16_bf16 v[144:159], a[0:3], v[112:115], v[144:159]
    ds_read_b64_tr_b16 a[16:17], v4 offset:12288
    ds_read_b64_tr_b16 a[18:19], v5 offset:1536
    s_waitcnt lgkmcnt(6)
    v_mfma_f32_32x32x16_bf16 v[144:159], a[4:7], v[116:119], v[144:159]
    ds_read_b64_tr_b16 a[0:1], v4 offset:12800
    ds_read_b64_tr_b16 a[2:3], v5 offset:1024
    s_waitcnt lgkmcnt(6)
    v_mfma_f32_32x32x16_bf16 v[144:159], a[8:11], v[120:123], v[144:159]
    ds_read_b64_tr_b16 a[4:5], v4 offset:13312
    ds_read_b64_tr_b16 a[6:7], v5 offset:512
    s_waitcnt lgkmcnt(6)
    v_mfma_f32_32x32x16_bf16 v[144:159], a[12:15], v[124:127], v[144:159]
    ds_read_b64_tr_b16 a[8:9], v4 offset:13824
    ds_read_b64_tr_b16 a[10:11], v5 offset:0
    s_waitcnt lgkmcnt(6)
    v_mfma_f32_32x32x16_bf16 v[144:159], a[16:19], v[128:131], v[144:159]
    s_waitcnt lgkmcnt(4)
    v_mfma_f32_32x32x16_bf16 v[144:159], a[0:3], v[132:135], v[144:159]
    s_waitcnt lgkmcnt(2)
    v_mfma_f32_32x32x16_bf16 v[144:159], a[4:7], v[136:139], v[144:159]
    s_waitcnt lgkmcnt(0)
    v_mfma_f32_32x32x16_bf16 v[144:159], a[8:11], v[140:143], v[144:159]
    ds_read_b128 v[160:163], v10 offset:0
    ds_read_b128 v[164:167], v10 offset:32
    ds_read_b128 v[168:171], v10 offset:64
    ds_read_b128 v[172:175], v10 offset:96
    s_waitcnt lgkmcnt(0)
    s_nop 6
    v_pk_fma_f32 v[144:145], v[160:161], v[12:13], v[144:145] op_sel_hi:[1,0,1]
    v_pk_fma_f32 v[146:147], v[162:163], v[12:13], v[146:147] op_sel_hi:[1,0,1]
    v_pk_fma_f32 v[148:149], v[164:165], v[12:13], v[148:149] op_sel_hi:[1,0,1]
    v_pk_fma_f32 v[150:151], v[166:167], v[12:13], v[150:151] op_sel_hi:[1,0,1]
    v_pk_fma_f32 v[152:153], v[168:169], v[12:13], v[152:153] op_sel_hi:[1,0,1]
    v_pk_fma_f32 v[154:155], v[170:171], v[12:13], v[154:155] op_sel_hi:[1,0,1]
    v_pk_fma_f32 v[156:157], v[172:173], v[12:13], v[156:157] op_sel_hi:[1,0,1]
    v_pk_fma_f32 v[158:159], v[174:175], v[12:13], v[158:159] op_sel_hi:[1,0,1]
    v_cvt_pk_bf16_f32 v144, v144, v145
    v_cvt_pk_bf16_f32 v145, v146, v147
    v_cvt_pk_bf16_f32 v146, v148, v149
    v_cvt_pk_bf16_f32 v147, v150, v151
    v_cvt_pk_bf16_f32 v148, v152, v153
    v_cvt_pk_bf16_f32 v149, v154, v155
    v_cvt_pk_bf16_f32 v150, v156, v157
    v_cvt_pk_bf16_f32 v151, v158, v159
    v_mfma_f32_32x32x16_bf16 v[176:191], a[32:35], v[144:147], 0
    s_nop 0
    v_mfma_f32_32x32x16_bf16 v[176:191], a[36:39], v[148:151], v[176:191]
    s_nop 11
    v_max3_f32 v18, v176, v177, v178
    v_max3_f32 v19, -v176, -v177, -v178
    v_max3_f32 v18, v18, v179, v180
    v_max3_f32 v19, v19, -v179, -v180
    v_max3_f32 v18, v18, v181, v182
    v_max3_f32 v19, v19, -v181, -v182
    v_max3_f32 v18, v18, v184, v185
    v_max3_f32 v19, v19, -v184, -v185
    v_max3_f32 v18, v18, v186, v187
    v_max3_f32 v19, v19, -v186, -v187
    v_max3_f32 v18, v18, v188, v189
    v_max3_f32 v19, v19, -v188, -v189
    v_max_f32 v18, v18, v190
    v_max_f32_e64 v19, v19, -v190
    s_nop 1
    v_permlane32_swap_b32 v18, v19
    v_max_f32 v18, v18, v19
    v_mul_f32_e64 v20, -v18, v16
    v_mul_f32_e64 v22, -v18, v16
    s_nop 1
    v_permlane32_swap_b32 v20, v22
    v_pk_fma_f32 v[192:193], v[176:177], v[16:17], v[20:21] op_sel_hi:[1,0,0]
    v_pk_fma_f32 v[194:195], v[178:179], v[16:17], v[20:21] op_sel_hi:[1,0,0]
    v_pk_fma_f32 v[196:197], v[180:181], v[16:17], v[20:21] op_sel_hi:[1,0,0]
    v_pk_fma_f32 v[200:201], v[184:185], v[16:17], v[20:21] op_sel_hi:[1,0,0]
    v_pk_fma_f32 v[202:203], v[186:187], v[16:17], v[20:21] op_sel_hi:[1,0,0]
    v_pk_fma_f32 v[204:205], v[188:189], v[16:17], v[20:21] op_sel_hi:[1,0,0]
    v_fma_f32 v198, v182, v16, v20
    v_fma_f32 v206, v190, v16, v20
    v_exp_f32 v192, v192
    v_exp_f32 v193, v193
    v_exp_f32 v194, v194
    v_exp_f32 v195, v195
    v_exp_f32 v196, v196
    v_exp_f32 v197, v197
    v_exp_f32 v198, v198
    v_exp_f32 v200, v200
    v_exp_f32 v201, v201
    v_exp_f32 v202, v202
    v_exp_f32 v203, v203
    v_exp_f32 v204, v204
    v_exp_f32 v205, v205
    v_exp_f32 v206, v206
    v_pk_fma_f32 v[176:177], v[176:177], v[16:17], v[22:23] op_sel_hi:[1,0,0] neg_lo:[1,0,0] neg_hi:[1,0,0]
    v_pk_fma_f32 v[178:179], v[178:179], v[16:17], v[22:23] op_sel_hi:[1,0,0] neg_lo:[1,0,0] neg_hi:[1,0,0]
    v_pk_fma_f32 v[180:181], v[180:181], v[16:17], v[22:23] op_sel_hi:[1,0,0] neg_lo:[1,0,0] neg_hi:[1,0,0]
    v_pk_fma_f32 v[184:185], v[184:185], v[16:17], v[22:23] op_sel_hi:[1,0,0] neg_lo:[1,0,0] neg_hi:[1,0,0]
    v_pk_fma_f32 v[186:187], v[186:187], v[16:17], v[22:23] op_sel_hi:[1,0,0] neg_lo:[1,0,0] neg_hi:[1,0,0]
    v_pk_fma_f32 v[188:189], v[188:189], v[16:17], v[22:23] op_sel_hi:[1,0,0] neg_lo:[1,0,0] neg_hi:[1,0,0]
    v_fma_f32 v182, -v182, v16, v22
    v_fma_f32 v190, -v190, v16, v22
    v_exp_f32 v176, v176
    v_exp_f32 v177, v177
    v_exp_f32 v178, v178
    v_exp_f32 v179, v179
    v_exp_f32 v180, v180
    v_exp_f32 v181, v181
    v_exp_f32 v182, v182
    v_exp_f32 v184, v184
    v_exp_f32 v185, v185
    v_exp_f32 v186, v186
    v_exp_f32 v187, v187
    v_exp_f32 v188, v188
    v_exp_f32 v189, v189
    v_exp_f32 v190, v190
    v_pk_add_f32 v[20:21], v[192:193], v[194:195]
    v_pk_add_f32 v[22:23], v[176:177], v[178:179]
    v_pk_add_f32 v[20:21], v[20:21], v[196:197]
    v_pk_add_f32 v[22:23], v[22:23], v[180:181]
    v_pk_add_f32 v[20:21], v[20:21], v[200:201]
    v_pk_add_f32 v[22:23], v[22:23], v[184:185]
    v_pk_add_f32 v[20:21], v[20:21], v[202:203]
    v_pk_add_f32 v[22:23], v[22:23], v[186:187]
    v_pk_add_f32 v[20:21], v[20:21], v[204:205]
    v_pk_add_f32 v[22:23], v[22:23], v[188:189]
    v_add_f32 v20, v20, v198
    v_add_f32 v21, v21, v206
    v_add_f32 v22, v22, v182
    v_add_f32 v23, v23, v190
    v_add_f32 v20, v20, v21
    v_add_f32 v22, v22, v23
    s_nop 1
    v_permlane32_swap_b32 v20, v22
    v_add_f32 v18, v20, v22
    v_rcp_f32 v20, v18
    v_rcp_f32 v22, v18
    s_nop 1
    v_permlane32_swap_b32 v20, v22
    v_pk_mul_f32 v[192:193], v[192:193], v[20:21] op_sel_hi:[1,0]
    v_pk_mul_f32 v[194:195], v[194:195], v[20:21] op_sel_hi:[1,0]
    v_pk_mul_f32 v[196:197], v[196:197], v[20:21] op_sel_hi:[1,0]
    v_pk_mul_f32 v[200:201], v[200:201], v[20:21] op_sel_hi:[1,0]
    v_pk_mul_f32 v[202:203], v[202:203], v[20:21] op_sel_hi:[1,0]
    v_pk_mul_f32 v[204:205], v[204:205], v[20:21] op_sel_hi:[1,0]
    v_mul_f32 v198, v198, v20
    v_mul_f32 v206, v206, v20
    v_cvt_pk_bf16_f32 v144, v192, v193
    v_cvt_pk_bf16_f32 v145, v194, v195
    v_cvt_pk_bf16_f32 v146, v196, v197
    v_cvt_pk_bf16_f32 v147, v198, 0
    v_cvt_pk_bf16_f32 v148, v200, v201
    v_cvt_pk_bf16_f32 v149, v202, v203
    v_cvt_pk_bf16_f32 v150, v204, v205
    v_cvt_pk_bf16_f32 v151, v206, 0
    v_pk_mul_f32 v[176:177], v[176:177], v[22:23] op_sel_hi:[1,0]
    v_pk_mul_f32 v[178:179], v[178:179], v[22:23] op_sel_hi:[1,0]
    v_pk_mul_f32 v[180:181], v[180:181], v[22:23] op_sel_hi:[1,0]
    v_pk_mul_f32 v[184:185], v[184:185], v[22:23] op_sel_hi:[1,0]
    v_pk_mul_f32 v[186:187], v[186:187], v[22:23] op_sel_hi:[1,0]
    v_pk_mul_f32 v[188:189], v[188:189], v[22:23] op_sel_hi:[1,0]
    v_mul_f32 v182, v182, v22
    v_mul_f32 v190, v190, v22
    v_cvt_pk_bf16_f32 v152, v176, v177
    v_cvt_pk_bf16_f32 v153, v178, v179
    v_cvt_pk_bf16_f32 v154, v180, v181
    v_cvt_pk_bf16_f32 v155, v182, 0
    v_cvt_pk_bf16_f32 v156, v184, v185
    v_cvt_pk_bf16_f32 v157, v186, v187
    v_cvt_pk_bf16_f32 v158, v188, v189
    v_cvt_pk_bf16_f32 v159, v190, 0
    s_lshl_b32 s57, s50, 13
    s_add_u32 s55, s57, s17
    s_add_u32 s56, s55, 4096
    s_add_u32 s57, s57, 93696
    v_add_u32 v15, s57, v1
    v_and_b32 v14, 7, v0
    v_lshlrev_b32 v14, 10, v14
    s_and_b32 s62, s49, 1
    s_sub_u32 s71, 14, s62
    s_mul_i32 s62, s62, 14
    s_mul_i32 s3, s50, 5
    s_add_u32 s62, s62, s3
    s_lshl_b32 s62, s62, 10
    s_add_u32 s62, s62, s17
    s_add_u32 s62, s62, 32768
    s_sub_u32 s71, s71, s3
    s_lshl_b32 s3, s3, 10
    s_add_u32 s3, s3, 126464
    v_add_u32 v17, s3, v1
    s_min_u32 s45, s71, 4
    s_lshl_b32 s45, s45, 10
    s_add_u32 s45, s45, s62
    s_add_u32 s46, s17, 61440
    s_cmp_lg_u32 s50, 3
    s_cbranch_scc1 L_nof_98
    v_bfe_u32 v18, v0, 1, 4
    v_and_b32 v21, 31, v0
    v_cmp_eq_u32 vcc, 1, v21
    s_nop 1
    v_cndmask_b32_e64 v18, v18, 16, vcc
    v_and_b32 v19, 1, v0
    v_lshlrev_b32 v19, 3, v19
    v_cndmask_b32_e64 v19, v19, 0, vcc
    v_lshrrev_b32 v20, 5, v0
    v_lshlrev_b32 v20, 2, v20
    v_mad_u32_u24 v19, v20, v18, v19
    v_cvt_f32_u32 v18, v18
    v_cvt_f32_u32 v19, v19
    v_mul_f32 v18, 0x3d000000, v18
    v_mul_f32 v19, 0x3d000000, v19
    v_lshlrev_b32 v21, 2, v21
    v_lshlrev_b32 v20, 2, v20
    v_add_u32 v22, 151040, v1
    v_fmamk_f32 v160, v18, 0x0, v19
    v_fmamk_f32 v161, v18, 0x3f800000, v19
    v_fmamk_f32 v162, v18, 0x40000000, v19
    v_fmamk_f32 v163, v18, 0x40400000, v19
    v_fmamk_f32 v164, v18, 0x41000000, v19
    v_fmamk_f32 v165, v18, 0x41100000, v19
    v_fmamk_f32 v166, v18, 0x41200000, v19
    v_fmamk_f32 v167, v18, 0x41300000, v19
    v_fmamk_f32 v168, v18, 0x41800000, v19
    v_fmamk_f32 v169, v18, 0x41880000, v19
    v_fmamk_f32 v170, v18, 0x41900000, v19
    v_fmamk_f32 v171, v18, 0x41980000, v19
    v_fmamk_f32 v172, v18, 0x41c00000, v19
    v_fmamk_f32 v173, v18, 0x41c80000, v19
    v_fmamk_f32 v174, v18, 0x41d00000, v19
    v_fmamk_f32 v175, v18, 0x41d80000, v19
    v_cos_f32 v160, v160
    v_cos_f32 v161, v161
    v_cos_f32 v162, v162
    v_cos_f32 v163, v163
    v_cos_f32 v164, v164
    v_cos_f32 v165, v165
    v_cos_f32 v166, v166
    v_cos_f32 v167, v167
    v_cos_f32 v168, v168
    v_cos_f32 v169, v169
    v_cos_f32 v170, v170
    v_cos_f32 v171, v171
    v_cos_f32 v172, v172
    v_cos_f32 v173, v173
    v_cos_f32 v174, v174
    v_cos_f32 v175, v175
L_nof_98:
    v_and_b32 v88, 15, v0
    s_and_b32 s3, s50, 1
    s_lshl_b32 s3, s3, 4
    v_add_u32 v88, s3, v88
    v_sub_u32 v89, 31, v88
    v_and_b32 v90, 16, v0
    v_lshlrev_b32 v90, 5, v90
    v_lshrrev_b32 v91, 5, v0
    v_lshl_add_u32 v90, v91, 3, v90
    v_lshl_add_u32 v99, v88, 4, v90
    v_lshl_add_u32 v100, v89, 4, v90
    v_add_u32 v100, 196608, v100
    s_cmp_eq_u32 s49, 0
    s_cselect_b32 vcc_lo, 0xffff, 0
    s_mov_b32 vcc_hi, 0
    v_cndmask_b32_e64 v102, 1.0, 0, vcc
    v_and_b32 v101, 48, v0
    v_add_lshl_u32 v101, v101, v0, 3
    v_add_u32 v101, 142848, v101
    s_and_b32 s24, s50, 2
    s_lshl_b32 s24, s24, 4
    s_add_u32 s24, s24, s48
    s_sub_u32 s25, 64, s24
    s_add_u32 s3, s24, 16
    s_cmp_eq_u32 s48, 0
    s_cselect_b32 s25, s3, s25
    s_mov_b64 s[12:13], s[34:35]
    s_mov_b32 s14, 1835008
    s_mov_b32 s15, 0x20000
    v_lshl_add_u32 v94, v88, 6, s24
    v_lshl_add_u32 v95, v89, 6, s25
    s_mov_b32 vcc_lo, 0xffff0000
    s_mov_b32 vcc_hi, 0xffff0000
    v_cndmask_b32 v94, v94, v95, vcc
    v_mul_u32_u24 v98, 896, v94
    s_lshl_b32 s3, s49, 5
    v_lshl_add_u32 v95, v91, 4, s3
    v_add_u32 v96, v98, v95
    v_sub_u32 v97, v98, v95
    v_add_u32 v97, 882, v97
    v_lshl_add_u32 v192, v88, 6, s24
    v_cvt_f32_u32 v192, v192
    v_mul_f32 v192, 0x3a000000, v192
    v_and_b32 v193, 48, v0
    v_cvt_f32_u32 v193, v193
    v_mul_f32 v193, 0.5, v193
    v_mul_f32 v193, v193, v192
    v_fmamk_f32 v176, v192, 0x0, v193
    v_fmamk_f32 v177, v192, 0x3f800000, v193
    v_fmamk_f32 v178, v192, 0x40000000, v193
    v_fmamk_f32 v179, v192, 0x40400000, v193
    v_fmamk_f32 v180, v192, 0x40800000, v193
    v_fmamk_f32 v181, v192, 0x40a00000, v193
    v_fmamk_f32 v182, v192, 0x40c00000, v193
    v_fmamk_f32 v183, v192, 0x40e00000, v193
    v_sin_f32_e64 v184, -v176
    v_cos_f32 v176, v176
    v_sin_f32_e64 v185, -v177
    v_cos_f32 v177, v177
    v_sin_f32_e64 v186, -v178
    v_cos_f32 v178, v178
    v_sin_f32_e64 v187, -v179
    v_cos_f32 v179, v179
    v_sin_f32_e64 v188, -v180
    v_cos_f32 v180, v180
    v_sin_f32_e64 v189, -v181
    v_cos_f32 v181, v181
    v_sin_f32_e64 v190, -v182
    v_cos_f32 v182, v182
    v_sin_f32_e64 v191, -v183
    v_cos_f32 v183, v183
    v_cvt_pk_bf16_f32 v120, v184, v185
    v_cvt_pk_bf16_f32 v112, v176, v177
    v_cvt_pk_bf16_f32 v121, v186, v187
    v_cvt_pk_bf16_f32 v113, v178, v179
    v_cvt_pk_bf16_f32 v122, v188, v189
    v_cvt_pk_bf16_f32 v114, v180, v181
    v_cvt_pk_bf16_f32 v123, v190, v191
    v_cvt_pk_bf16_f32 v115, v182, v183
    v_fmamk_f32 v176, v192, 0x42000000, v193
    v_fmamk_f32 v177, v192, 0x42040000, v193
    v_fmamk_f32 v178, v192, 0x42080000, v193
    v_fmamk_f32 v179, v192, 0x420c0000, v193
    v_fmamk_f32 v180, v192, 0x42100000, v193
    v_fmamk_f32 v181, v192, 0x42140000, v193
    v_fmamk_f32 v182, v192, 0x42180000, v193
    v_fmamk_f32 v183, v192, 0x421c0000, v193
    v_sin_f32_e64 v184, -v176
    v_cos_f32 v176, v176
    v_sin_f32_e64 v185, -v177
    v_cos_f32 v177, v177
    v_sin_f32_e64 v186, -v178
    v_cos_f32 v178, v178
    v_sin_f32_e64 v187, -v179
    v_cos_f32 v179, v179
    v_sin_f32_e64 v188, -v180
    v_cos_f32 v180, v180
    v_sin_f32_e64 v189, -v181
    v_cos_f32 v181, v181
    v_sin_f32_e64 v190, -v182
    v_cos_f32 v182, v182
    v_sin_f32_e64 v191, -v183
    v_cos_f32 v183, v183
    v_cvt_pk_bf16_f32 v124, v184, v185
    v_cvt_pk_bf16_f32 v116, v176, v177
    v_cvt_pk_bf16_f32 v125, v186, v187
    v_cvt_pk_bf16_f32 v117, v178, v179
    v_cvt_pk_bf16_f32 v126, v188, v189
    v_cvt_pk_bf16_f32 v118, v180, v181
    v_cvt_pk_bf16_f32 v127, v190, v191
    v_cvt_pk_bf16_f32 v119, v182, v183
    s_setprio 2
    s_barrier
    ds_read_b128 v[32:35], v9 offset:0
    ds_read_b128 v[36:39], v9 offset:512
    ds_read_b128 v[40:43], v9 offset:1024
    ds_read_b128 v[44:47], v9 offset:1536
    s_waitcnt lgkmcnt(3)
    v_mfma_f32_32x32x16_bf16 v[176:191], v[32:35], v[144:147], 0
    s_waitcnt lgkmcnt(2)
    v_mfma_f32_32x32x16_bf16 v[176:191], v[36:39], v[148:151], v[176:191]
    s_waitcnt lgkmcnt(1)
    v_mfma_f32_32x32x16_bf16 v[176:191], v[40:43], v[152:155], v[176:191]
    s_waitcnt lgkmcnt(0)
    v_mfma_f32_32x32x16_bf16 v[176:191], v[44:47], v[156:159], v[176:191]
    s_nop 11
    v_add_f32 v12, 0x358637bd, v183
    v_rcp_f32 v12, v12
    s_nop 0
    v_pk_mul_f32 v[176:177], v[176:177], v[12:13] op_sel_hi:[1,0]
    v_pk_mul_f32 v[178:179], v[178:179], v[12:13] op_sel_hi:[1,0]
    v_pk_mul_f32 v[180:181], v[180:181], v[12:13] op_sel_hi:[1,0]
    v_pk_mul_f32 v[182:183], v[182:183], v[12:13] op_sel_hi:[1,0]
    v_pk_mul_f32 v[184:185], v[184:185], v[12:13] op_sel_hi:[1,0]
    v_pk_mul_f32 v[186:187], v[186:187], v[12:13] op_sel_hi:[1,0]
    v_pk_mul_f32 v[188:189], v[188:189], v[12:13] op_sel_hi:[1,0]
    v_pk_mul_f32 v[190:191], v[190:191], v[12:13] op_sel_hi:[1,0]
    v_cvt_pk_bf16_f32 v192, v176, v177
    v_cvt_pk_bf16_f32 v193, v178, v179
    v_cvt_pk_bf16_f32 v194, v180, v181
    v_cvt_pk_bf16_f32 v195, v182, v2
    v_cvt_pk_bf16_f32 v196, v184, v185
    v_cvt_pk_bf16_f32 v197, v186, v187
    v_cvt_pk_bf16_f32 v198, v188, v189
    v_cvt_pk_bf16_f32 v199, v190, v2
    s_cmp_eq_u32 s52, 0
    s_cbranch_scc0 L_slow_99
    buffer_store_dwordx4 v[192:195], v1, s[4:7], s37 offen offset:0
    buffer_store_dwordx4 v[196:199], v1, s[4:7], s37 offen offset:1024
    s_branch L_done_100
L_slow_99:
    buffer_store_dwordx4 v[192:195], v1, s[4:7], s37 offen offset:0 sc1
    buffer_store_dwordx4 v[196:199], v1, s[4:7], s37 offen offset:1024 sc1
L_done_100:
    s_sleep 6
L_o_101:
    s_mov_b32 m0, s57
    buffer_load_dword v16, v14, s[4:7], s55 offen offset:1020 sc1
    buffer_load_dwordx4 v[32:35], v1, s[4:7], s55 offen offset:0 sc1
    buffer_load_dwordx4 v[36:39], v1, s[4:7], s55 offen offset:1024 sc1
    s_waitcnt vmcnt(2)
    v_xor_b32 v16, s70, v16
    v_cmp_lt_u32 vcc, 0xffff, v16
    s_nop 0
    s_cbranch_vccz L_ok_102
    s_cmp_eq_u32 s53, 0
    s_cbranch_scc1 L_ok_102
    s_sub_u32 s53, s53, 1
    s_branch L_o_101
L_ok_102:
    buffer_load_dwordx4 v1, s[4:7], s55 offen offset:2048 sc1 lds
    buffer_load_dwordx4 v1, s[4:7], s55 offen offset:3072 sc1 lds
    s_waitcnt vmcnt(2)
    ds_write_b128 v15, v[32:35] offset:0
    ds_write_b128 v15, v[36:39] offset:1024
    s_add_u32 m0, s57, 4096
    s_nop 0
    buffer_load_dwordx4 v1, s[4:7], s56 offen offset:0 sc1 lds
    buffer_load_dwordx4 v1, s[4:7], s56 offen offset:1024 sc1 lds
    buffer_load_dwordx4 v1, s[4:7], s56 offen offset:2048 sc1 lds
    buffer_load_dwordx4 v1, s[4:7], s56 offen offset:3072 sc1 lds
    v_xor_b32 v16, v35, v2
    v_bitop3_b32 v16, v16, v39, v2 bitop3:0xf6
    v_cmp_lt_u32 vcc, 0xffff, v16
    s_nop 0
    s_cbranch_vccz L_rg_104
L_rt_103:
    buffer_load_dwordx4 v[32:35], v1, s[4:7], s55 offen offset:0 sc1
    buffer_load_dwordx4 v[36:39], v1, s[4:7], s55 offen offset:1024 sc1
    s_waitcnt vmcnt(0)
    ds_write_b128 v15, v[32:35] offset:0
    ds_write_b128 v15, v[36:39] offset:1024
    s_waitcnt vmcnt(0)
    v_xor_b32 v16, v35, v2
    v_bitop3_b32 v16, v16, v39, v2 bitop3:0xf6
    v_cmp_lt_u32 vcc, 0xffff, v16
    s_nop 0
    s_cbranch_vccz L_ok_105
    s_cmp_eq_u32 s53, 0
    s_cbranch_scc1 L_ok_105
    s_sub_u32 s53, s53, 1
    s_branch L_rt_103
L_ok_105:
L_rg_104:
    s_waitcnt lgkmcnt(0)
    s_waitcnt vmcnt(6)
    s_barrier
    s_waitcnt vmcnt(4)
    s_barrier
    s_waitcnt vmcnt(2)
    s_barrier
    s_waitcnt vmcnt(0)
    s_barrier
    s_barrier
    v_mov_b32 v16, 60160
    ds_read_b32 v16, v16
    s_waitcnt lgkmcnt(0)
    v_cmp_ne_u32 vcc, 0, v16
    s_nop 0
    s_cbranch_vccnz L_o_101
    s_cmp_lg_u32 s50, 3
    s_cbranch_scc1 L_nof_106
    s_sleep 5
    buffer_load_dwordx4 v[48:51], v1, s[4:7], s46 offen offset:0 sc1
    buffer_load_dwordx4 v[52:55], v1, s[4:7], s46 offen offset:1024 sc1
    buffer_load_dwordx4 v[56:59], v1, s[4:7], s46 offen offset:2048 sc1
    buffer_load_dwordx4 v[60:63], v1, s[4:7], s46 offen offset:3072 sc1
    s_waitcnt vmcnt(0)
    v_max3_u32 v16, v48, v49, v50
    v_max3_u32 v16, v16, v51, v52
    v_max3_u32 v16, v16, v53, v54
    v_max3_u32 v16, v16, v55, v56
    v_max3_u32 v16, v16, v57, v58
    v_max3_u32 v16, v16, v59, v60
    v_max_u32 v16, v16, v61
    v_cmp_eq_u32 vcc, -1, v16
    s_nop 0
    s_cbranch_vccnz L_sl_107
    v_add_f32 v48, v48, v49
    v_add_f32 v50, v50, v51
    v_add_f32 v52, v52, v53
    v_add_f32 v54, v54, v55
    v_add_f32 v56, v56, v57
    v_add_f32 v58, v58, v59
    v_add_f32 v60, v60, v61
    v_add_f32 v48, v48, v50
    v_add_f32 v52, v52, v54
    v_add_f32 v56, v56, v58
    v_add_f32 v48, v48, v52
    v_add_f32 v56, v56, v60
    v_add_f32 v48, v48, v56
    v_mul_f32 v48, 0x3b124925, v48
    v_mov_b32 v49, v48
    s_nop 1
    v_permlane32_swap_b32 v48, v49
    v_fma_f32 v49, -v48, v48, v49
    v_max_f32 v49, 0, v49
    v_add_f32 v49, 0x3727c5ac, v49
    v_rsq_f32 v16, v49
    s_barrier
    s_branch L_sj_108
L_sl_107:
    buffer_load_dwordx4 v[48:51], v1, s[4:7], s46 offen offset:0 sc1
    buffer_load_dwordx4 v[52:55], v1, s[4:7], s46 offen offset:1024 sc1
    buffer_load_dwordx4 v[56:59], v1, s[4:7], s46 offen offset:2048 sc1
    buffer_load_dwordx4 v[60:63], v1, s[4:7], s46 offen offset:3072 sc1
    s_barrier
    s_waitcnt vmcnt(0)
    v_max3_u32 v16, v48, v49, v50
    v_max3_u32 v16, v16, v51, v52
    v_max3_u32 v16, v16, v53, v54
    v_max3_u32 v16, v16, v55, v56
    v_max3_u32 v16, v16, v57, v58
    v_max3_u32 v16, v16, v59, v60
    v_max_u32 v16, v16, v61
    v_cmp_eq_u32 vcc, -1, v16
    s_nop 0
    s_cbranch_vccz L_rg_110
L_rt_109:
    buffer_load_dwordx4 v[48:51], v1, s[4:7], s46 offen offset:0 sc1
    buffer_load_dwordx4 v[52:55], v1, s[4:7], s46 offen offset:1024 sc1
    buffer_load_dwordx4 v[56:59], v1, s[4:7], s46 offen offset:2048 sc1
    buffer_load_dwordx4 v[60:63], v1, s[4:7], s46 offen offset:3072 sc1
    s_waitcnt vmcnt(0)
    v_max3_u32 v16, v48, v49, v50
    v_max3_u32 v16, v16, v51, v52
    v_max3_u32 v16, v16, v53, v54
    v_max3_u32 v16, v16, v55, v56
    v_max3_u32 v16, v16, v57, v58
    v_max3_u32 v16, v16, v59, v60
    v_max_u32 v16, v16, v61
    v_cmp_eq_u32 vcc, -1, v16
    s_nop 0
    s_cbranch_vccz L_ok_111
    s_cmp_eq_u32 s53, 0
    s_cbranch_scc1 L_ok_111
    s_sub_u32 s53, s53, 1
    s_branch L_rt_109
L_ok_111:
L_rg_110:
    v_add_f32 v48, v48, v49
    v_add_f32 v50, v50, v51
    v_add_f32 v52, v52, v53
    v_add_f32 v54, v54, v55
    v_add_f32 v56, v56, v57
    v_add_f32 v58, v58, v59
    v_add_f32 v60, v60, v61
    v_add_f32 v48, v48, v50
    v_add_f32 v52, v52, v54
    v_add_f32 v56, v56, v58
    v_add_f32 v48, v48, v52
    v_add_f32 v56, v56, v60
    v_add_f32 v48, v48, v56
    v_mul_f32 v48, 0x3b124925, v48
    v_mov_b32 v49, v48
    s_nop 1
    v_permlane32_swap_b32 v48, v49
    v_fma_f32 v49, -v48, v48, v49
    v_max_f32 v49, 0, v49
    v_add_f32 v49, 0x3727c5ac, v49
    v_rsq_f32 v16, v49
L_sj_108:
    s_nop 0
    ds_write_b32 v21, v16 offset:59520
    ds_read_b128 v[64:67], v20 offset:59520
    ds_read_b128 v[68:71], v20 offset:59552
    ds_read_b128 v[72:75], v20 offset:59584
    ds_read_b128 v[76:79], v20 offset:59616
    s_waitcnt lgkmcnt(3)
    v_mul_f32 v64, v64, v160
    v_mul_f32 v65, v65, v161
    v_mul_f32 v66, v66, v162
    v_mul_f32 v67, v67, v163
    v_cvt_pk_bf16_f32 v80, v64, v65
    v_cvt_pk_bf16_f32 v81, v66, v67
    s_waitcnt lgkmcnt(2)
    v_mul_f32 v68, v68, v164
    v_mul_f32 v69, v69, v165
    v_mul_f32 v70, v70, v166
    v_mul_f32 v71, v71, v167
    v_cvt_pk_bf16_f32 v82, v68, v69
    v_cvt_pk_bf16_f32 v83, v70, v71
    s_waitcnt lgkmcnt(1)
    v_mul_f32 v72, v72, v168
    v_mul_f32 v73, v73, v169
    v_mul_f32 v74, v74, v170
    v_mul_f32 v75, v75, v171
    v_cvt_pk_bf16_f32 v84, v72, v73
    v_cvt_pk_bf16_f32 v85, v74, v75
    s_waitcnt lgkmcnt(0)
    v_mul_f32 v76, v76, v172
    v_mul_f32 v77, v77, v173
    v_mul_f32 v78, v78, v174
    v_mul_f32 v79, v79, v175
    v_cvt_pk_bf16_f32 v86, v76, v77
    v_cvt_pk_bf16_f32 v87, v78, v79
    ds_write_b128 v22, v[80:83]
    ds_write_b128 v22, v[84:87] offset:1024
    s_waitcnt lgkmcnt(0)
    s_branch L_fj_112
L_nof_106:
    s_sleep 3
L_xe_113:
    buffer_load_dwordx4 v[32:35], v1, s[4:7], s62 offen offset:0 sc1
    buffer_load_dwordx4 v[36:39], v1, s[4:7], s62 offen offset:1024 sc1
    buffer_load_dwordx4 v[40:43], v1, s[4:7], s62 offen offset:2048 sc1
    buffer_load_dwordx4 v[44:47], v1, s[4:7], s62 offen offset:3072 sc1
    buffer_load_dwordx4 v[48:51], v1, s[4:7], s45 offen sc1
    s_waitcnt vmcnt(4)
    ds_write_b128 v17, v[32:35] offset:0
    s_waitcnt vmcnt(3)
    ds_write_b128 v17, v[36:39] offset:1024
    s_waitcnt vmcnt(2)
    ds_write_b128 v17, v[40:43] offset:2048
    s_waitcnt vmcnt(1)
    ds_write_b128 v17, v[44:47] offset:3072
    s_waitcnt vmcnt(0)
    ds_write_b128 v17, v[48:51] offset:4096
    v_max3_u32 v16, v32, v36, v40
    v_max3_u32 v16, v16, v44, v48
    v_cmp_eq_u32 vcc, -1, v16
    s_nop 0
    s_cbranch_vccz L_ok_114
    s_cmp_eq_u32 s53, 0
    s_cbranch_scc1 L_ok_114
    s_sub_u32 s53, s53, 1
    s_branch L_xe_113
L_ok_114:
    s_waitcnt lgkmcnt(0)
    s_barrier
L_fj_112:
    s_barrier
    s_setprio 0
    s_lshl_b32 s54, s49, 10
    s_add_u32 s54, s54, s18
    s_add_u32 s44, s54, 32768
    s_add_u32 s45, s54, 47104
    s_barrier
    s_cmp_ge_u32 s49, 14
    s_cbranch_scc1 L_g4skip_115
    buffer_load_dwordx2 v[64:65], v99, s[4:7], s44 offen sc1
    buffer_load_dwordx2 v[66:67], v99, s[4:7], s45 offen sc1
    buffer_load_dwordx2 v[68:69], v100, s[4:7], s44 offen sc1
    buffer_load_dwordx2 v[70:71], v100, s[4:7], s45 offen sc1
    s_cmp_lg_u32 s48, 0
    s_cbranch_scc1 L_nz_116
    v_lshl_add_u32 v192, v89, 6, s25
    v_cvt_f32_u32 v192, v192
    v_mul_f32 v192, 0x3a000000, v192
    v_and_b32 v193, 48, v0
    v_cvt_f32_u32 v193, v193
    v_mul_f32 v193, 0.5, v193
    v_mul_f32 v193, v193, v192
    v_fmamk_f32 v176, v192, 0x0, v193
    v_fmamk_f32 v177, v192, 0x3f800000, v193
    v_fmamk_f32 v178, v192, 0x40000000, v193
    v_fmamk_f32 v179, v192, 0x40400000, v193
    v_fmamk_f32 v180, v192, 0x40800000, v193
    v_fmamk_f32 v181, v192, 0x40a00000, v193
    v_fmamk_f32 v182, v192, 0x40c00000, v193
    v_fmamk_f32 v183, v192, 0x40e00000, v193
    v_sin_f32_e64 v184, -v176
    v_cos_f32 v176, v176
    v_sin_f32_e64 v185, -v177
    v_cos_f32 v177, v177
    v_sin_f32_e64 v186, -v178
    v_cos_f32 v178, v178
    v_sin_f32_e64 v187, -v179
    v_cos_f32 v179, v179
    v_sin_f32_e64 v188, -v180
    v_cos_f32 v180, v180
    v_sin_f32_e64 v189, -v181
    v_cos_f32 v181, v181
    v_sin_f32_e64 v190, -v182
    v_cos_f32 v182, v182
    v_sin_f32_e64 v191, -v183
    v_cos_f32 v183, v183
    v_cvt_pk_bf16_f32 v136, v184, v185
    v_cvt_pk_bf16_f32 v128, v176, v177
    v_cvt_pk_bf16_f32 v137, v186, v187
    v_cvt_pk_bf16_f32 v129, v178, v179
    v_cvt_pk_bf16_f32 v138, v188, v189
    v_cvt_pk_bf16_f32 v130, v180, v181
    v_cvt_pk_bf16_f32 v139, v190, v191
    v_cvt_pk_bf16_f32 v131, v182, v183
    v_fmamk_f32 v176, v192, 0x42000000, v193
    v_fmamk_f32 v177, v192, 0x42040000, v193
    v_fmamk_f32 v178, v192, 0x42080000, v193
    v_fmamk_f32 v179, v192, 0x420c0000, v193
    v_fmamk_f32 v180, v192, 0x42100000, v193
    v_fmamk_f32 v181, v192, 0x42140000, v193
    v_fmamk_f32 v182, v192, 0x42180000, v193
    v_fmamk_f32 v183, v192, 0x421c0000, v193
    v_sin_f32_e64 v184, -v176
    v_cos_f32 v176, v176
    v_sin_f32_e64 v185, -v177
    v_cos_f32 v177, v177
    v_sin_f32_e64 v186, -v178
    v_cos_f32 v178, v178
    v_sin_f32_e64 v187, -v179
    v_cos_f32 v179, v179
    v_sin_f32_e64 v188, -v180
    v_cos_f32 v180, v180
    v_sin_f32_e64 v189, -v181
    v_cos_f32 v181, v181
    v_sin_f32_e64 v190, -v182
    v_cos_f32 v182, v182
    v_sin_f32_e64 v191, -v183
    v_cos_f32 v183, v183
    v_cvt_pk_bf16_f32 v140, v184, v185
    v_cvt_pk_bf16_f32 v132, v176, v177
    v_cvt_pk_bf16_f32 v141, v186, v187
    v_cvt_pk_bf16_f32 v133, v178, v179
    v_cvt_pk_bf16_f32 v142, v188, v189
    v_cvt_pk_bf16_f32 v134, v180, v181
    v_cvt_pk_bf16_f32 v143, v190, v191
    v_cvt_pk_bf16_f32 v135, v182, v183
L_nz_116:
    s_waitcnt vmcnt(0)
    v_max3_u32 v18, v64, v66, v68
    v_max_u32 v18, v18, v70
    v_cmp_eq_u32 vcc, -1, v18
    s_nop 0
    s_cbranch_vccz L_rg_118
L_rt_117:
    buffer_load_dwordx2 v[64:65], v99, s[4:7], s44 offen sc1
    buffer_load_dwordx2 v[66:67], v99, s[4:7], s45 offen sc1
    buffer_load_dwordx2 v[68:69], v100, s[4:7], s44 offen sc1
    buffer_load_dwordx2 v[70:71], v100, s[4:7], s45 offen sc1
    s_waitcnt vmcnt(0)
    v_max3_u32 v18, v64, v66, v68
    v_max_u32 v18, v18, v70
    v_cmp_eq_u32 vcc, -1, v18
    s_nop 0
    s_cbranch_vccz L_ok_119
    s_cmp_eq_u32 s53, 0
    s_cbranch_scc1 L_ok_119
    s_sub_u32 s53, s53, 1
    s_branch L_rt_117
L_ok_119:
L_rg_118:
    v_lshlrev_b32 v144, 16, v64
    v_and_b32 v145, 0xffff0000, v64
    v_lshlrev_b32 v146, 16, v65
    v_and_b32 v147, 0xffff0000, v65
    v_lshlrev_b32 v148, 16, v66
    v_and_b32 v149, 0xffff0000, v66
    v_lshlrev_b32 v150, 16, v67
    v_and_b32 v151, 0xffff0000, v67
    v_pk_add_f32 v[72:73], v[144:145], v[148:149]
    v_pk_add_f32 v[76:77], v[144:145], v[148:149] neg_lo:[0,1] neg_hi:[0,1]
    v_pk_add_f32 v[74:75], v[146:147], v[150:151]
    v_pk_add_f32 v[78:79], v[146:147], v[150:151] neg_lo:[0,1] neg_hi:[0,1]
    v_lshlrev_b32 v144, 16, v68
    v_and_b32 v145, 0xffff0000, v68
    v_lshlrev_b32 v146, 16, v69
    v_and_b32 v147, 0xffff0000, v69
    v_lshlrev_b32 v148, 16, v70
    v_and_b32 v149, 0xffff0000, v70
    v_lshlrev_b32 v150, 16, v71
    v_and_b32 v151, 0xffff0000, v71
    v_pk_add_f32 v[80:81], v[144:145], v[148:149]
    v_pk_add_f32 v[84:85], v[144:145], v[148:149] neg_lo:[0,1] neg_hi:[0,1]
    v_pk_add_f32 v[82:83], v[146:147], v[150:151]
    v_pk_add_f32 v[86:87], v[146:147], v[150:151] neg_lo:[0,1] neg_hi:[0,1]
    v_pk_mul_f32 v[72:73], v[72:73], 0.5 op_sel_hi:[1,0]
    v_pk_mul_f32 v[74:75], v[74:75], 0.5 op_sel_hi:[1,0]
    v_pk_mul_f32 v[76:77], v[76:77], 0.5 op_sel_hi:[1,0]
    v_pk_mul_f32 v[78:79], v[78:79], 0.5 op_sel_hi:[1,0]
    v_pk_mul_f32 v[80:81], v[80:81], 0.5 op_sel_hi:[1,0]
    v_pk_mul_f32 v[82:83], v[82:83], 0.5 op_sel_hi:[1,0]
    v_pk_mul_f32 v[84:85], v[84:85], 0.5 op_sel_hi:[1,0]
    v_pk_mul_f32 v[86:87], v[86:87], 0.5 op_sel_hi:[1,0]
    s_setprio 2
    s_barrier
    ds_read_b64_tr_b16 v[32:33], v101 offset:0
    ds_read_b64_tr_b16 v[34:35], v101 offset:128
    ds_read_b64_tr_b16 v[36:37], v101 offset:1024
    ds_read_b64_tr_b16 v[38:39], v101 offset:1152
    ds_read_b64_tr_b16 v[40:41], v101 offset:2048
    ds_read_b64_tr_b16 v[42:43], v101 offset:2176
    ds_read_b64_tr_b16 v[44:45], v101 offset:3072
    ds_read_b64_tr_b16 v[46:47], v101 offset:3200
    ds_read_b64_tr_b16 v[48:49], v101 offset:4096
    ds_read_b64_tr_b16 v[50:51], v101 offset:4224
    ds_read_b64_tr_b16 v[52:53], v101 offset:5120
    ds_read_b64_tr_b16 v[54:55], v101 offset:5248
    ds_read_b64_tr_b16 v[56:57], v101 offset:6144
    ds_read_b64_tr_b16 v[58:59], v101 offset:6272
    ds_read_b64_tr_b16 v[60:61], v101 offset:7168
    ds_read_b64_tr_b16 v[62:63], v101 offset:7296
    s_waitcnt lgkmcnt(12)
    v_mfma_f32_16x16x32_bf16 v[144:147], v[32:35], v[112:115], 0
    v_mfma_f32_16x16x32_bf16 v[144:147], v[36:39], v[116:119], v[144:147]
    s_waitcnt lgkmcnt(8)
    v_mfma_f32_16x16x32_bf16 v[148:151], v[40:43], v[120:123], 0
    v_mfma_f32_16x16x32_bf16 v[148:151], v[44:47], v[124:127], v[148:151]
    s_cmp_eq_u32 s48, 0
    s_cbranch_scc1 L_rho0_120
    s_waitcnt lgkmcnt(4)
    v_mfma_f32_16x16x32_bf16 v[152:155], v[48:51], v[120:123], 0
    v_mfma_f32_16x16x32_bf16 v[152:155], v[52:55], v[124:127], v[152:155]
    s_waitcnt lgkmcnt(0)
    v_mfma_f32_16x16x32_bf16 v[148:151], v[56:59], v[112:115], v[148:151]
    v_mfma_f32_16x16x32_bf16 v[148:151], v[60:63], v[116:119], v[148:151]
    s_nop 4
    v_pk_add_f32 v[144:145], v[144:145], v[152:153] neg_lo:[0,1] neg_hi:[0,1]
    v_pk_add_f32 v[146:147], v[146:147], v[154:155] neg_lo:[0,1] neg_hi:[0,1]
    s_nop 0
    v_pk_add_f32 v[160:161], v[144:145], v[148:149] neg_lo:[0,1] neg_hi:[0,1]
    v_pk_add_f32 v[168:169], v[144:145], v[148:149]
    v_pk_add_f32 v[162:163], v[146:147], v[150:151] neg_lo:[0,1] neg_hi:[0,1]
    v_pk_add_f32 v[170:171], v[146:147], v[150:151]
    v_pk_add_f32 v[164:165], v[168:169], v[76:77]
    v_pk_add_f32 v[172:173], v[160:161], v[84:85]
    v_pk_add_f32 v[166:167], v[170:171], v[78:79]
    v_pk_add_f32 v[174:175], v[162:163], v[86:87]
    s_branch L_cj_121
L_rho0_120:
    s_waitcnt lgkmcnt(4)
    v_mfma_f32_16x16x32_bf16 v[152:155], v[48:51], v[128:131], 0
    v_mfma_f32_16x16x32_bf16 v[152:155], v[52:55], v[132:135], v[152:155]
    s_waitcnt lgkmcnt(0)
    v_mfma_f32_16x16x32_bf16 v[156:159], v[56:59], v[136:139], 0
    v_mfma_f32_16x16x32_bf16 v[156:159], v[60:63], v[140:143], v[156:159]
    v_pk_add_f32 v[160:161], v[144:145], v[148:149] neg_lo:[0,1] neg_hi:[0,1]
    v_pk_add_f32 v[164:165], v[144:145], v[148:149]
    s_nop 5
    v_pk_add_f32 v[168:169], v[152:153], v[156:157] neg_lo:[0,1] neg_hi:[0,1]
    v_pk_add_f32 v[172:173], v[152:153], v[156:157]
    v_pk_add_f32 v[162:163], v[146:147], v[150:151] neg_lo:[0,1] neg_hi:[0,1]
    v_pk_add_f32 v[166:167], v[146:147], v[150:151]
    v_pk_add_f32 v[170:171], v[154:155], v[158:159] neg_lo:[0,1] neg_hi:[0,1]
    v_pk_add_f32 v[174:175], v[154:155], v[158:159]
    v_pk_add_f32 v[164:165], v[164:165], v[76:77]
    v_pk_add_f32 v[172:173], v[172:173], v[84:85]
    v_pk_add_f32 v[166:167], v[166:167], v[78:79]
    v_pk_add_f32 v[174:175], v[174:175], v[86:87]
L_cj_121:
    v_fma_f32 v160, v160, v102, v72
    v_add_f32 v161, v161, v73
    v_pk_add_f32 v[162:163], v[162:163], v[74:75]
    v_fma_f32 v168, v168, v102, v80
    v_add_f32 v169, v169, v81
    v_pk_add_f32 v[170:171], v[170:171], v[82:83]
    v_cvt_pk_bf16_f32 v176, v160, v161
    v_cvt_pk_bf16_f32 v177, v162, v163
    v_cvt_pk_bf16_f32 v178, v168, v169
    v_cvt_pk_bf16_f32 v179, v170, v171
    v_cvt_pk_bf16_f32 v182, v167, v166
    v_cvt_pk_bf16_f32 v183, v165, v164
    v_permlane16_swap_b32 v176, v178
    v_permlane16_swap_b32 v177, v179
    v_cvt_pk_bf16_f32 v180, v175, v174
    v_cvt_pk_bf16_f32 v181, v173, v172
    buffer_store_dwordx4 v[176:179], v96, s[12:15], 0 offen
    v_permlane16_swap_b32 v182, v180
    v_permlane16_swap_b32 v183, v181
    s_cmp_lg_u32 s49, 0
    s_cbranch_scc1 L_nz_122
    s_mov_b32 exec_hi, 0
    buffer_store_dwordx3 v[180:182], v97, s[12:15], 0 offen
    buffer_store_short v183, v97, s[12:15], 0 offen offset:12
    buffer_store_short_d16_hi v183, v98, s[12:15], 0 offen offset:448
    s_not_b64 exec, exec
L_nz_122:
    buffer_store_dwordx4 v[180:183], v97, s[12:15], 0 offen
    s_mov_b64 exec, -1
L_g4skip_115:
L_end:
    s_endpgm
.section .rodata,"a"
.p2align 6
.amdhsa_kernel interleave_layers__linear_kernel_hedgehog__spectral_fnet__prompt_kernel
  .amdhsa_next_free_vgpr 256
  .amdhsa_next_free_sgpr 102
  .amdhsa_accum_offset 208
  .amdhsa_group_segment_fixed_size 0
  .amdhsa_kernarg_size 96
  .amdhsa_user_sgpr_count 2
  .amdhsa_user_sgpr_kernarg_segment_ptr 1
  .amdhsa_system_sgpr_workgroup_id_x 1
  .amdhsa_float_denorm_mode_32 3
.end_amdhsa_kernel
```
